```python
import torch

def _softmax(x, axis=-1):
    return torch.softmax(x, dim=axis)
def _gelu(x):
    return torch.nn.functional.gelu(x, approximate="tanh")
def _silu(x):
    return torch.nn.functional.silu(x)
def _sigmoid(x):
    return torch.sigmoid(x)
def _layernorm(x, axis=-1, eps=1e-5):
    m = x.mean(dim=axis, keepdim=True)
    v = x.var(dim=axis, keepdim=True, unbiased=False)
    return (x - m) / torch.sqrt(v + eps)
def _scatter_add(tgt, idx, src, axis=0):
    return tgt.clone().index_add_(axis, idx, src)
def _segment_sum(src, seg, n):
    out = torch.zeros((n,) + src.shape[1:], dtype=src.dtype)
    return out.index_add_(0, seg, src)
def _pad(x, pw):
    flat = tuple(v for pair in reversed(pw) for v in pair)
    return torch.nn.functional.pad(x, flat)

kernel_name = 'concat_heads__mha_block_cached__mha_block_cached__near_ridge'

def setup_inputs():

    _w = (lambda a: (lambda t: t.to(torch.bfloat16) if t.is_floating_point() else t)(torch.as_tensor(a)))
    def _A_setup():
        B, Sq, D = 8, 128, 512
        H, Sk, Dh = 32, 512, 128
        return {
            "x": _w((lambda *s: torch.randn(*s, dtype=torch.bfloat16) * 0.8)(B, Sq, D)),
            "k_cache": _w((lambda *s: torch.randn(*s, dtype=torch.bfloat16) * 0.8)(B, H, Sk, Dh)),
            "v_cache": _w((lambda *s: torch.randn(*s, dtype=torch.bfloat16) * 0.05)(B, H, Sk, Dh)),
            "wq": _w((lambda *s: torch.randn(*s, dtype=torch.bfloat16) * 0.8)(D, H * Dh) * (D ** -0.5)),
            "wo": _w((lambda *s: torch.randn(*s, dtype=torch.bfloat16) * 0.05)(H * Dh, D) * ((H * Dh) ** -0.5)),
        }
    _A_in = _A_setup()

    def _B_setup():
        B, Sq, D = 8, 128, 512
        H, Sk, Dh = 32, 512, 128
        return {
            "x": _w((lambda *s: torch.randn(*s, dtype=torch.bfloat16) * 0.8)(B, Sq, D)),
            "k_cache": _w((lambda *s: torch.randn(*s, dtype=torch.bfloat16) * 0.8)(B, H, Sk, Dh)),
            "v_cache": _w((lambda *s: torch.randn(*s, dtype=torch.bfloat16) * 0.05)(B, H, Sk, Dh)),
            "wq": _w((lambda *s: torch.randn(*s, dtype=torch.bfloat16) * 0.8)(D, H * Dh) * (D ** -0.5)),
            "wo": _w((lambda *s: torch.randn(*s, dtype=torch.bfloat16) * 0.05)(H * Dh, D) * ((H * Dh) ** -0.5)),
        }
    _B_in = _B_setup()

    return {
        "A_x": _A_in["x"],
        "A_k_cache": _A_in["k_cache"],
        "A_v_cache": _A_in["v_cache"],
        "A_wq": _A_in["wq"],
        "A_wo": _A_in["wo"],
        "B_x": _B_in["x"],
        "B_k_cache": _B_in["k_cache"],
        "B_v_cache": _B_in["v_cache"],
        "B_wq": _B_in["wq"],
        "B_wo": _B_in["wo"],
    }

def reference(A_x, A_k_cache, A_v_cache, A_wq, A_wo, B_x, B_k_cache, B_v_cache, B_wq, B_wo):
    def _A_ref(x, k_cache, v_cache, wq, wo):
        B, Sq, D = x.shape
        H, Dh = 32, 128
        q = (lambda x, *d: x.permute(*d))((x @ wq).reshape(B, Sq, H, Dh), 0, 2, 1, 3)
        scores = torch.einsum("bhqd,bhkd->bhqk", q, k_cache) * (Dh ** -0.5)
        p = _softmax(scores, axis=-1)
        o = torch.einsum("bhqk,bhkd->bhqd", p, v_cache)
        return (lambda x, *d: x.permute(*d))(o, 0, 2, 1, 3).reshape(B, Sq, H * Dh) @ wo

    def _B_ref(x, k_cache, v_cache, wq, wo):
        B, Sq, D = x.shape
        H, Dh = 32, 128
        q = (lambda x, *d: x.permute(*d))((x @ wq).reshape(B, Sq, H, Dh), 0, 2, 1, 3)
        scores = torch.einsum("bhqd,bhkd->bhqk", q, k_cache) * (Dh ** -0.5)
        p = _softmax(scores, axis=-1)
        o = torch.einsum("bhqk,bhkd->bhqd", p, v_cache)
        return (lambda x, *d: x.permute(*d))(o, 0, 2, 1, 3).reshape(B, Sq, H * Dh) @ wo

    a = _A_ref(A_x, A_k_cache, A_v_cache, A_wq, A_wo)
    b = _B_ref(B_x, B_k_cache, B_v_cache, B_wq, B_wo)
    return torch.concatenate([a, b], axis=-1)
```

```asm
; @launch grid=(256,1,1) block=(512,1,1) lds=163840
.amdgcn_target "amdgcn-amd-amdhsa--gfx950"
.text
.globl concat_heads__mha_block_cached__mha_block_cached__near_ridge_kernel
.p2align 8
.type concat_heads__mha_block_cached__mha_block_cached__near_ridge_kernel,@function
concat_heads__mha_block_cached__mha_block_cached__near_ridge_kernel:
    s_cmp_ge_u32 s2, 256
    s_cbranch_scc1 L_end
    s_and_b32 s21, s2, 7
    s_and_b32 s6, s21, 1
    s_mul_i32 s23, s6, 40
    s_add_u32 s46, s0, s23
    s_addc_u32 s47, s1, 0
    s_load_dwordx4 s[48:51], s[46:47], 0
    s_load_dwordx4 s[52:55], s[46:47], 16
    s_load_dwordx2 s[56:57], s[0:1], 96
    s_load_dwordx2 s[100:101], s[46:47], 32
    s_load_dwordx4 s[84:87], s[0:1], 80

    v_lshrrev_b32 v1, 6, v0
    s_lshr_b32 s22, s2, 3
    v_readfirstlane_b32 s3, v1
    v_and_b32 v1, 63, v0
    v_lshlrev_b32 v30, 4, v1

    s_and_b32 s7, s22, 7
    s_lshr_b32 s83, s21, 1
    s_lshl_b32 s23, s83, 3
    s_lshr_b32 s82, s22, 3
    s_xor_b32 s82, s82, 0
    s_mov_b32 s20, s82
    s_add_u32 s20, s20, s23
    s_lshl_b32 s59, s82, 1
    s_add_u32 s59, s59, s7

    s_mul_i32 s23, s82, 1
    s_mul_i32 s74, s7, 1
    s_add_u32 s74, s74, s23
    s_mul_i32 s23, s83, 0
    s_add_u32 s74, s74, s23

    s_and_b32 s74, s74, 7
    s_lshl_b32 s74, s74, 14

    s_lshr_b32 s4, s3, 2
    s_and_b32 s5, s3, 3
    s_lshl_b32 s45, s3, 10
    s_lshl_b32 s58, s3, 11

    v_lshrrev_b32 v206, 4, v1
    v_and_b32 v207, 15, v1
    v_lshlrev_b32 v208, 2, v206
    v_xor_b32 v208, v208, v207
    v_lshlrev_b32 v208, 4, v208
    v_lshl_or_b32 v16, v206, 8, v208
    v_lshl_or_b32 v18, v206, 13, v208
    s_and_b32 s23, s3, 1
    s_lshl_b32 s22, s23, 2
    v_add_u32 v208, s22, v206
    v_and_b32 v209, 7, v1
    v_xor_b32 v208, v208, v209
    v_lshlrev_b32 v208, 4, v208
    v_lshrrev_b32 v209, 3, v1
    v_lshl_or_b32 v17, v209, 10, v208
    s_lshl_b32 s22, s23, 3

    v_add_u32 v208, s22, v206
    v_add_u32 v208, 0, v208
    v_xor_b32 v208, v208, v207
    v_lshlrev_b32 v208, 4, v208
    v_lshl_or_b32 v14, v206, 8, v208

    v_add_u32 v208, s22, v206
    v_add_u32 v208, 4, v208
    v_xor_b32 v208, v208, v207
    v_lshlrev_b32 v208, 4, v208
    v_lshl_or_b32 v15, v206, 8, v208

    s_lshl_b32 s72, s3, 13
    s_lshl_b32 s73, s3, 15
    s_lshl_b32 s23, s20, 8
    s_add_u32 s73, s73, s23
    s_lshl_b32 s36, s20, 17
    s_add_u32 s36, s36, s58
    s_lshl_b32 s42, s5, 18
    s_lshl_b32 s23, s20, 13
    s_add_u32 s42, s42, s23
    s_mov_b32 s43, 0x49800000
    s_mov_b32 s44, 0x3e0293ee
    s_mov_b32 s10, 0x20000
    s_mov_b32 s11, 0x20000
    s_mov_b32 s14, 0x400000
    s_mov_b32 s15, 0x20000
    s_mov_b32 s18, 0x400000
    s_mov_b32 s19, 0x20000
    s_mov_b32 s26, 0x400000
    s_mov_b32 s27, 0x20000
    s_mov_b32 s30, 0x100000
    s_mov_b32 s31, 0x20000

    s_add_u32 s35, s59, 0
    s_and_b32 s35, s35, 7
    s_lshl_b32 s37, s35, 7
    s_add_u32 s37, s37, s72
    s_lshl_b32 s39, s35, 19
    s_add_u32 s39, s39, s73

    s_add_u32 s35, s59, 1
    s_and_b32 s35, s35, 7
    s_lshl_b32 s38, s35, 7
    s_add_u32 s38, s38, s72
    s_lshl_b32 s40, s35, 19
    s_add_u32 s40, s40, s73

    s_lshl_b32 s22, s7, 17
    s_lshl_b32 s23, s7, 22
    s_waitcnt lgkmcnt(0)
    s_add_u32 s8, s48, s22
    s_addc_u32 s9, s49, 0
    s_mov_b32 s12, s54
    s_mov_b32 s13, s55

    s_add_u32 m0, s45, 98304
    s_add_u32 s32, s37, 0
    buffer_load_dwordx4 v17, s[8:11], s32 offen lds
    s_add_u32 m0, s45, 106496
    s_add_u32 s32, s37, 65536
    buffer_load_dwordx4 v17, s[8:11], s32 offen lds
    s_add_u32 m0, s45, 114688
    s_add_u32 s32, s39, 0
    buffer_load_dwordx4 v18, s[12:15], s32 offen lds
    s_add_u32 m0, s45, 122880
    s_add_u32 s32, s39, 1024
    buffer_load_dwordx4 v18, s[12:15], s32 offen lds
    s_add_u32 m0, s45, 131072
    s_add_u32 s32, s39, 262144
    buffer_load_dwordx4 v18, s[12:15], s32 offen lds
    s_add_u32 m0, s45, 139264
    s_add_u32 s32, s39, 263168
    buffer_load_dwordx4 v18, s[12:15], s32 offen lds
    s_add_u32 s88, s56, 33554432
    s_addc_u32 s89, s57, 0
    s_mov_b32 s90, 0x8000
    s_mov_b32 s91, 0x20000
    s_lshl_b32 s21, s6, 3
    s_add_u32 s21, s21, s7
    s_lshl_b32 s21, s21, 4
    s_lshl_b32 s22, s83, 2
    s_add_u32 s22, s22, s21
    s_lshl_b32 s54, s22, 7
    s_add_u32 s22, s22, s82
    s_lshl_b32 s75, s22, 7
    s_add_u32 s21, s21, s82
    s_lshl_b32 s55, s21, 7

    s_cmp_eq_u32 s3, 7
    s_cbranch_scc0 nz_1
    v_mov_b32 v252, 0
    v_mov_b32 v253, 0
    v_mov_b32 v254, 0
    v_mov_b32 v255, 0
    v_mov_b32 v251, 0
    s_mov_b64 exec, 1
    buffer_store_dwordx4 v[252:255], v251, s[88:91], s75 offen sc1
    s_mov_b64 exec, -1
nz_1:

    s_add_u32 s16, s50, s23
    s_addc_u32 s17, s51, 0
    s_add_u32 s24, s52, s23
    s_addc_u32 s25, s53, 0
    s_lshl_b32 s23, s6, 3
    s_add_u32 s23, s23, s7
    s_lshl_b32 s23, s23, 20
    s_add_u32 s28, s56, s23
    s_addc_u32 s29, s57, 0

    v_and_b32 v240, 31, v1
    v_lshrrev_b32 v241, 5, v1
    v_bfe_u32 v242, v1, 2, 2
    v_and_b32 v243, 3, v1
    v_bfe_u32 v244, v1, 4, 1
    v_and_b32 v245, 1, v243
    v_lshlrev_b32 v245, 1, v245
    v_lshrrev_b32 v246, 1, v243
    v_or_b32 v245, v245, v246
    v_lshlrev_b32 v245, 3, v245
    v_lshl_or_b32 v245, v244, 5, v245

    v_lshl_add_u32 v246, v241, 3, v242
    v_lshlrev_b32 v246, 8, v246
    v_add_u32 v246, v246, v245
    s_lshl_b32 s23, s4, 13
    v_add_u32 v246, s23, v246

    v_xor_b32 v247, 0, v242
    v_lshl_add_u32 v247, v247, 6, v246
    v_add_u32 v180, 98304, v247
    v_add_u32 v184, 32768, v247

    v_xor_b32 v247, 1, v242
    v_lshl_add_u32 v247, v247, 6, v246
    v_add_u32 v181, 98304, v247
    v_add_u32 v185, 32768, v247

    v_xor_b32 v247, 2, v242
    v_lshl_add_u32 v247, v247, 6, v246
    v_add_u32 v182, 98304, v247
    v_add_u32 v186, 32768, v247

    v_xor_b32 v247, 3, v242
    v_lshl_add_u32 v247, v247, 6, v246
    v_add_u32 v183, 98304, v247
    v_add_u32 v187, 32768, v247

    s_and_b32 s23, s5, 1
    s_lshl_b32 s23, s23, 5
    v_add_u32 v246, s23, v240
    v_bfe_u32 v247, v246, 1, 3
    v_xor_b32 v247, v247, v241
    v_lshlrev_b32 v247, 4, v247
    v_lshl_or_b32 v247, v246, 7, v247
    s_lshr_b32 s23, s5, 1
    s_lshl_b32 s23, s23, 13
    s_add_u32 s23, s23, 98304
    v_add_u32 v176, s23, v247

    v_xor_b32 v177, 32, v176
    v_xor_b32 v178, 64, v176
    v_xor_b32 v179, 96, v176
    s_lshl_b32 s23, s4, 5
    v_add_u32 v246, s23, v240
    v_and_b32 v247, 15, v240
    v_xor_b32 v247, v247, v241
    v_lshlrev_b32 v247, 4, v247
    v_lshl_or_b32 v2, v246, 8, v247

    v_xor_b32 v3, 32, v2
    v_xor_b32 v4, 64, v2
    v_xor_b32 v5, 96, v2
    v_xor_b32 v6, 128, v2
    v_xor_b32 v7, 160, v2
    v_xor_b32 v8, 192, v2
    v_xor_b32 v9, 224, v2
    v_lshl_add_u32 v246, v241, 2, v242
    v_add_u32 v246, s23, v246
    v_lshlrev_b32 v246, 8, v246
    v_add_u32 v246, 49152, v246
    v_add_u32 v246, v246, v245

    v_xor_b32 v247, 0, v242
    v_lshl_add_u32 v10, v247, 6, v246

    v_xor_b32 v247, 1, v242
    v_lshl_add_u32 v11, v247, 6, v246

    v_xor_b32 v247, 2, v242
    v_lshl_add_u32 v12, v247, 6, v246

    v_xor_b32 v247, 3, v242
    v_lshl_add_u32 v13, v247, 6, v246

    s_lshl_b32 s23, s3, 13
    s_add_u32 s23, s23, 98304
    v_add_u32 v28, s23, v30
    s_xor_b32 s23, s3, 4
    s_lshl_b32 s23, s23, 13
    s_add_u32 s23, s23, 98304
    v_add_u32 v29, s23, v30
    s_lshl_b32 s23, s5, 13
    s_add_u32 s23, s23, 98304
    v_add_u32 v31, s23, v30

    s_mov_b32 s92, s100
    s_mov_b32 s93, s101
    s_mov_b32 s94, 0x400000
    s_mov_b32 s95, 0x20000
    s_mov_b32 s96, s86
    s_mov_b32 s97, s87
    s_mov_b32 s98, 256
    s_mov_b32 s99, 0x20000
    v_and_b32 v248, 3, v1
    v_lshlrev_b32 v249, 9, v248
    v_lshlrev_b32 v248, 7, v248

    s_and_b32 s21, s3, 1
    s_lshl_b32 s21, s21, 1
    s_bfe_u32 s22, s3, 0x10001
    s_or_b32 s21, s21, s22
    s_and_b32 s22, s3, 4
    s_or_b32 s21, s21, s22
    s_lshl_b32 s21, s21, 12
    s_lshl_b32 s22, s82, 8
    s_add_u32 s21, s21, s22
    s_lshl_b32 s22, s5, 18
    s_lshl_b32 s23, s4, 12
    s_add_u32 s22, s22, s23

    s_add_u32 s23, s82, 1
    s_and_b32 s23, s23, 3
    s_mov_b32 s23, s23
    s_lshl_b32 s34, s83, 3
    s_add_u32 s23, s23, s34
    s_lshl_b32 s46, s23, 17
    s_add_u32 s46, s46, s21
    s_lshl_b32 s50, s23, 13
    s_add_u32 s50, s50, s22

    s_add_u32 s23, s82, 2
    s_and_b32 s23, s23, 3
    s_mov_b32 s23, s23
    s_lshl_b32 s34, s83, 3
    s_add_u32 s23, s23, s34
    s_lshl_b32 s47, s23, 17
    s_add_u32 s47, s47, s21
    s_lshl_b32 s51, s23, 13
    s_add_u32 s51, s51, s22

    s_add_u32 s23, s82, 3
    s_and_b32 s23, s23, 3
    s_mov_b32 s23, s23
    s_lshl_b32 s34, s83, 3
    s_add_u32 s23, s23, s34
    s_lshl_b32 s48, s23, 17
    s_add_u32 s48, s48, s21
    s_lshl_b32 s52, s23, 13
    s_add_u32 s52, s52, s22

    s_add_u32 s23, s82, 4
    s_and_b32 s23, s23, 3
    s_mov_b32 s23, s23
    s_lshl_b32 s34, s83, 3
    s_add_u32 s23, s23, s34
    s_lshl_b32 s49, s23, 17
    s_add_u32 s49, s49, s21
    s_lshl_b32 s53, s23, 13
    s_add_u32 s53, s53, s22

    s_waitcnt vmcnt(2)
    s_barrier
    ds_read_b128 v[200:203], v176 offset:0
    ds_read_b64_tr_b16 v[204:205], v180 offset:16384
    ds_read_b64_tr_b16 v[206:207], v180 offset:17408
    ds_read_b64_tr_b16 v[208:209], v181 offset:16384
    ds_read_b64_tr_b16 v[210:211], v181 offset:17408
    ds_read_b64_tr_b16 v[212:213], v182 offset:16384
    ds_read_b64_tr_b16 v[214:215], v182 offset:17408
    ds_read_b64_tr_b16 v[216:217], v183 offset:16384
    ds_read_b64_tr_b16 v[218:219], v183 offset:17408
    s_waitcnt lgkmcnt(6)
    v_mfma_f32_32x32x16_bf16 v[96:111], v[204:207], v[200:203], 0
    ds_read_b128 v[220:223], v177 offset:0
    ds_read_b64_tr_b16 v[224:225], v180 offset:20480
    ds_read_b64_tr_b16 v[226:227], v180 offset:21504
    s_add_u32 m0, s45, 147456
    s_add_u32 s32, s38, 0
    buffer_load_dwordx4 v17, s[8:11], s32 offen lds
    s_waitcnt lgkmcnt(7)
    v_mfma_f32_32x32x16_bf16 v[112:127], v[208:211], v[200:203], 0
    ds_read_b64_tr_b16 v[228:229], v181 offset:20480
    ds_read_b64_tr_b16 v[230:231], v181 offset:21504
    s_add_u32 m0, s45, 155648
    s_add_u32 s32, s38, 65536
    buffer_load_dwordx4 v17, s[8:11], s32 offen lds
    s_waitcnt lgkmcnt(7)
    v_mfma_f32_32x32x16_bf16 v[128:143], v[212:215], v[200:203], 0
    ds_read_b64_tr_b16 v[232:233], v182 offset:20480
    ds_read_b64_tr_b16 v[234:235], v182 offset:21504
    s_waitcnt lgkmcnt(7)
    v_mfma_f32_32x32x16_bf16 v[144:159], v[216:219], v[200:203], 0
    ds_read_b64_tr_b16 v[236:237], v183 offset:20480
    ds_read_b64_tr_b16 v[238:239], v183 offset:21504
    s_waitcnt lgkmcnt(0)
    s_waitcnt vmcnt(2)
    s_barrier
    v_mfma_f32_32x32x16_bf16 v[96:111], v[224:227], v[220:223], v[96:111]
    ds_read_b128 v[200:203], v178 offset:0
    ds_read_b64_tr_b16 v[204:205], v180 offset:32768
    ds_read_b64_tr_b16 v[206:207], v180 offset:33792
    s_add_u32 m0, s45, 32768
    s_add_u32 s32, s40, 0
    buffer_load_dwordx4 v18, s[12:15], s32 offen lds
    v_mfma_f32_32x32x16_bf16 v[112:127], v[228:231], v[220:223], v[112:127]
    ds_read_b64_tr_b16 v[208:209], v181 offset:32768
    ds_read_b64_tr_b16 v[210:211], v181 offset:33792
    s_add_u32 m0, s45, 40960
    s_add_u32 s32, s40, 1024
    buffer_load_dwordx4 v18, s[12:15], s32 offen lds
    v_mfma_f32_32x32x16_bf16 v[128:143], v[232:235], v[220:223], v[128:143]
    ds_read_b64_tr_b16 v[212:213], v182 offset:32768
    ds_read_b64_tr_b16 v[214:215], v182 offset:33792
    v_mfma_f32_32x32x16_bf16 v[144:159], v[236:239], v[220:223], v[144:159]
    ds_read_b64_tr_b16 v[216:217], v183 offset:32768
    ds_read_b64_tr_b16 v[218:219], v183 offset:33792
    s_waitcnt lgkmcnt(6)
    v_mfma_f32_32x32x16_bf16 v[96:111], v[204:207], v[200:203], v[96:111]
    ds_read_b128 v[220:223], v179 offset:0
    ds_read_b64_tr_b16 v[224:225], v180 offset:36864
    ds_read_b64_tr_b16 v[226:227], v180 offset:37888
    s_add_u32 m0, s45, 81920
    s_add_u32 s32, s40, 262144
    buffer_load_dwordx4 v18, s[12:15], s32 offen lds
    s_waitcnt lgkmcnt(7)
    v_mfma_f32_32x32x16_bf16 v[112:127], v[208:211], v[200:203], v[112:127]
    ds_read_b64_tr_b16 v[228:229], v181 offset:36864
    ds_read_b64_tr_b16 v[230:231], v181 offset:37888
    s_add_u32 m0, s45, 90112
    s_add_u32 s32, s40, 263168
    buffer_load_dwordx4 v18, s[12:15], s32 offen lds
    s_waitcnt lgkmcnt(7)
    v_mfma_f32_32x32x16_bf16 v[128:143], v[212:215], v[200:203], v[128:143]
    ds_read_b64_tr_b16 v[232:233], v182 offset:36864
    ds_read_b64_tr_b16 v[234:235], v182 offset:37888
    s_waitcnt lgkmcnt(7)
    v_mfma_f32_32x32x16_bf16 v[144:159], v[216:219], v[200:203], v[144:159]
    ds_read_b64_tr_b16 v[236:237], v183 offset:36864
    ds_read_b64_tr_b16 v[238:239], v183 offset:37888
    s_waitcnt lgkmcnt(0)
    s_waitcnt vmcnt(2)
    s_barrier
    v_mfma_f32_32x32x16_bf16 v[96:111], v[224:227], v[220:223], v[96:111]
    ds_read_b128 v[200:203], v176 offset:49152
    ds_read_b64_tr_b16 v[204:205], v184 offset:0
    ds_read_b64_tr_b16 v[206:207], v184 offset:1024
    s_add_u32 s35, s59, 2
    s_and_b32 s35, s35, 7
    s_lshl_b32 s37, s35, 7
    s_add_u32 s37, s37, s72
    s_lshl_b32 s39, s35, 19
    s_add_u32 s39, s39, s73

    s_add_u32 m0, s45, 98304
    s_add_u32 s32, s37, 0
    buffer_load_dwordx4 v17, s[8:11], s32 offen lds
    v_mfma_f32_32x32x16_bf16 v[112:127], v[228:231], v[220:223], v[112:127]
    ds_read_b64_tr_b16 v[208:209], v185 offset:0
    ds_read_b64_tr_b16 v[210:211], v185 offset:1024
    s_add_u32 m0, s45, 106496
    s_add_u32 s32, s37, 65536
    buffer_load_dwordx4 v17, s[8:11], s32 offen lds
    v_mfma_f32_32x32x16_bf16 v[128:143], v[232:235], v[220:223], v[128:143]
    ds_read_b64_tr_b16 v[212:213], v186 offset:0
    ds_read_b64_tr_b16 v[214:215], v186 offset:1024
    v_mfma_f32_32x32x16_bf16 v[144:159], v[236:239], v[220:223], v[144:159]
    ds_read_b64_tr_b16 v[216:217], v187 offset:0
    ds_read_b64_tr_b16 v[218:219], v187 offset:1024
    s_waitcnt lgkmcnt(6)
    v_mfma_f32_32x32x16_bf16 v[96:111], v[204:207], v[200:203], v[96:111]
    ds_read_b128 v[220:223], v177 offset:49152
    ds_read_b64_tr_b16 v[224:225], v184 offset:4096
    ds_read_b64_tr_b16 v[226:227], v184 offset:5120
    s_add_u32 m0, s45, 114688
    s_add_u32 s32, s39, 0
    buffer_load_dwordx4 v18, s[12:15], s32 offen lds
    s_waitcnt lgkmcnt(7)
    v_mfma_f32_32x32x16_bf16 v[112:127], v[208:211], v[200:203], v[112:127]
    ds_read_b64_tr_b16 v[228:229], v185 offset:4096
    ds_read_b64_tr_b16 v[230:231], v185 offset:5120
    s_add_u32 m0, s45, 122880
    s_add_u32 s32, s39, 1024
    buffer_load_dwordx4 v18, s[12:15], s32 offen lds
    s_waitcnt lgkmcnt(7)
    v_mfma_f32_32x32x16_bf16 v[128:143], v[212:215], v[200:203], v[128:143]
    ds_read_b64_tr_b16 v[232:233], v186 offset:4096
    ds_read_b64_tr_b16 v[234:235], v186 offset:5120
    s_waitcnt lgkmcnt(7)
    v_mfma_f32_32x32x16_bf16 v[144:159], v[216:219], v[200:203], v[144:159]
    ds_read_b64_tr_b16 v[236:237], v187 offset:4096
    ds_read_b64_tr_b16 v[238:239], v187 offset:5120
    s_waitcnt lgkmcnt(0)
    s_waitcnt vmcnt(4)
    s_barrier
    v_mfma_f32_32x32x16_bf16 v[96:111], v[224:227], v[220:223], v[96:111]
    ds_read_b128 v[200:203], v178 offset:49152
    ds_read_b64_tr_b16 v[204:205], v184 offset:49152
    ds_read_b64_tr_b16 v[206:207], v184 offset:50176
    s_add_u32 m0, s45, 131072
    s_add_u32 s32, s39, 262144
    buffer_load_dwordx4 v18, s[12:15], s32 offen lds
    v_mfma_f32_32x32x16_bf16 v[112:127], v[228:231], v[220:223], v[112:127]
    ds_read_b64_tr_b16 v[208:209], v185 offset:49152
    ds_read_b64_tr_b16 v[210:211], v185 offset:50176
    s_add_u32 m0, s45, 139264
    s_add_u32 s32, s39, 263168
    buffer_load_dwordx4 v18, s[12:15], s32 offen lds
    v_mfma_f32_32x32x16_bf16 v[128:143], v[232:235], v[220:223], v[128:143]
    ds_read_b64_tr_b16 v[212:213], v186 offset:49152
    ds_read_b64_tr_b16 v[214:215], v186 offset:50176
    v_mfma_f32_32x32x16_bf16 v[144:159], v[236:239], v[220:223], v[144:159]
    ds_read_b64_tr_b16 v[216:217], v187 offset:49152
    ds_read_b64_tr_b16 v[218:219], v187 offset:50176
    s_waitcnt lgkmcnt(6)
    v_mfma_f32_32x32x16_bf16 v[96:111], v[204:207], v[200:203], v[96:111]
    ds_read_b128 v[220:223], v179 offset:49152
    ds_read_b64_tr_b16 v[224:225], v184 offset:53248
    ds_read_b64_tr_b16 v[226:227], v184 offset:54272
    s_add_u32 s35, s59, 3
    s_and_b32 s35, s35, 7
    s_lshl_b32 s38, s35, 7
    s_add_u32 s38, s38, s72
    s_lshl_b32 s40, s35, 19
    s_add_u32 s40, s40, s73

    s_add_u32 m0, s45, 32768
    s_add_u32 s32, s40, 0
    buffer_load_dwordx4 v18, s[12:15], s32 offen lds
    s_waitcnt lgkmcnt(7)
    v_mfma_f32_32x32x16_bf16 v[112:127], v[208:211], v[200:203], v[112:127]
    ds_read_b64_tr_b16 v[228:229], v185 offset:53248
    ds_read_b64_tr_b16 v[230:231], v185 offset:54272
    s_add_u32 m0, s45, 40960
    s_add_u32 s32, s40, 1024
    buffer_load_dwordx4 v18, s[12:15], s32 offen lds
    s_waitcnt lgkmcnt(7)
    v_mfma_f32_32x32x16_bf16 v[128:143], v[212:215], v[200:203], v[128:143]
    ds_read_b64_tr_b16 v[232:233], v186 offset:53248
    ds_read_b64_tr_b16 v[234:235], v186 offset:54272
    s_waitcnt lgkmcnt(7)
    v_mfma_f32_32x32x16_bf16 v[144:159], v[216:219], v[200:203], v[144:159]
    ds_read_b64_tr_b16 v[236:237], v187 offset:53248
    ds_read_b64_tr_b16 v[238:239], v187 offset:54272
    s_waitcnt lgkmcnt(0)
    s_waitcnt vmcnt(4)
    s_barrier
    v_mfma_f32_32x32x16_bf16 v[96:111], v[224:227], v[220:223], v[96:111]
    ds_read_b128 v[200:203], v176 offset:0
    ds_read_b64_tr_b16 v[204:205], v180 offset:16384
    ds_read_b64_tr_b16 v[206:207], v180 offset:17408
    s_add_u32 m0, s45, 147456
    s_add_u32 s32, s38, 0
    buffer_load_dwordx4 v17, s[8:11], s32 offen lds
    v_mfma_f32_32x32x16_bf16 v[112:127], v[228:231], v[220:223], v[112:127]
    ds_read_b64_tr_b16 v[208:209], v181 offset:16384
    ds_read_b64_tr_b16 v[210:211], v181 offset:17408
    s_add_u32 m0, s45, 155648
    s_add_u32 s32, s38, 65536
    buffer_load_dwordx4 v17, s[8:11], s32 offen lds
    v_mfma_f32_32x32x16_bf16 v[128:143], v[232:235], v[220:223], v[128:143]
    ds_read_b64_tr_b16 v[212:213], v182 offset:16384
    ds_read_b64_tr_b16 v[214:215], v182 offset:17408
    v_mfma_f32_32x32x16_bf16 v[144:159], v[236:239], v[220:223], v[144:159]
    ds_read_b64_tr_b16 v[216:217], v183 offset:16384
    ds_read_b64_tr_b16 v[218:219], v183 offset:17408
    s_waitcnt lgkmcnt(6)
    v_mfma_f32_32x32x16_bf16 v[96:111], v[204:207], v[200:203], v[96:111]
    ds_read_b128 v[220:223], v177 offset:0
    ds_read_b64_tr_b16 v[224:225], v180 offset:20480
    ds_read_b64_tr_b16 v[226:227], v180 offset:21504
    s_add_u32 m0, s45, 81920
    s_add_u32 s32, s40, 262144
    buffer_load_dwordx4 v18, s[12:15], s32 offen lds
    s_waitcnt lgkmcnt(7)
    v_mfma_f32_32x32x16_bf16 v[112:127], v[208:211], v[200:203], v[112:127]
    ds_read_b64_tr_b16 v[228:229], v181 offset:20480
    ds_read_b64_tr_b16 v[230:231], v181 offset:21504
    s_add_u32 m0, s45, 90112
    s_add_u32 s32, s40, 263168
    buffer_load_dwordx4 v18, s[12:15], s32 offen lds
    s_waitcnt lgkmcnt(7)
    v_mfma_f32_32x32x16_bf16 v[128:143], v[212:215], v[200:203], v[128:143]
    ds_read_b64_tr_b16 v[232:233], v182 offset:20480
    ds_read_b64_tr_b16 v[234:235], v182 offset:21504
    s_waitcnt lgkmcnt(7)
    v_mfma_f32_32x32x16_bf16 v[144:159], v[216:219], v[200:203], v[144:159]
    ds_read_b64_tr_b16 v[236:237], v183 offset:20480
    ds_read_b64_tr_b16 v[238:239], v183 offset:21504
    s_waitcnt lgkmcnt(0)
    s_waitcnt vmcnt(6)
    s_barrier
    s_cmp_eq_u32 s3, 7
    s_cbranch_scc0 na_2
    s_lshl_b32 s34, s6, 3
    s_add_u32 s34, s34, s7
    s_lshl_b32 s34, s34, 4
    v_mov_b32 v255, s34
    v_mov_b32 v254, 1
    s_mov_b64 exec, 1
    buffer_atomic_add v254, v255, s[96:99], 0 offen sc1
    s_mov_b64 exec, -1
na_2:

    v_mfma_f32_32x32x16_bf16 v[96:111], v[224:227], v[220:223], v[96:111]
    ds_read_b128 v[200:203], v178 offset:0
    ds_read_b64_tr_b16 v[204:205], v180 offset:32768
    ds_read_b64_tr_b16 v[206:207], v180 offset:33792
    s_add_u32 s35, s59, 4
    s_and_b32 s35, s35, 7
    s_lshl_b32 s37, s35, 7
    s_add_u32 s37, s37, s72
    s_lshl_b32 s39, s35, 19
    s_add_u32 s39, s39, s73

    s_add_u32 m0, s45, 114688
    s_add_u32 s32, s39, 0
    buffer_load_dwordx4 v18, s[12:15], s32 offen lds
    v_mfma_f32_32x32x16_bf16 v[112:127], v[228:231], v[220:223], v[112:127]
    ds_read_b64_tr_b16 v[208:209], v181 offset:32768
    ds_read_b64_tr_b16 v[210:211], v181 offset:33792
    s_add_u32 m0, s45, 122880
    s_add_u32 s32, s39, 1024
    buffer_load_dwordx4 v18, s[12:15], s32 offen lds
    v_mfma_f32_32x32x16_bf16 v[128:143], v[232:235], v[220:223], v[128:143]
    ds_read_b64_tr_b16 v[212:213], v182 offset:32768
    ds_read_b64_tr_b16 v[214:215], v182 offset:33792
    v_mfma_f32_32x32x16_bf16 v[144:159], v[236:239], v[220:223], v[144:159]
    ds_read_b64_tr_b16 v[216:217], v183 offset:32768
    ds_read_b64_tr_b16 v[218:219], v183 offset:33792
    s_waitcnt lgkmcnt(6)
    v_mfma_f32_32x32x16_bf16 v[96:111], v[204:207], v[200:203], v[96:111]
    ds_read_b128 v[220:223], v179 offset:0
    ds_read_b64_tr_b16 v[224:225], v180 offset:36864
    ds_read_b64_tr_b16 v[226:227], v180 offset:37888
    s_waitcnt lgkmcnt(7)
    v_mfma_f32_32x32x16_bf16 v[112:127], v[208:211], v[200:203], v[112:127]
    ds_read_b64_tr_b16 v[228:229], v181 offset:36864
    ds_read_b64_tr_b16 v[230:231], v181 offset:37888
    s_waitcnt lgkmcnt(7)
    v_mfma_f32_32x32x16_bf16 v[128:143], v[212:215], v[200:203], v[128:143]
    ds_read_b64_tr_b16 v[232:233], v182 offset:36864
    ds_read_b64_tr_b16 v[234:235], v182 offset:37888
    s_waitcnt lgkmcnt(7)
    v_mfma_f32_32x32x16_bf16 v[144:159], v[216:219], v[200:203], v[144:159]
    ds_read_b64_tr_b16 v[236:237], v183 offset:36864
    ds_read_b64_tr_b16 v[238:239], v183 offset:37888
    s_waitcnt lgkmcnt(0)
    s_waitcnt vmcnt(4)
    s_barrier
    v_mfma_f32_32x32x16_bf16 v[96:111], v[224:227], v[220:223], v[96:111]
    ds_read_b128 v[200:203], v176 offset:49152
    ds_read_b64_tr_b16 v[204:205], v184 offset:0
    ds_read_b64_tr_b16 v[206:207], v184 offset:1024
    s_add_u32 m0, s45, 98304
    s_add_u32 s32, s37, 0
    buffer_load_dwordx4 v17, s[8:11], s32 offen lds
    v_mfma_f32_32x32x16_bf16 v[112:127], v[228:231], v[220:223], v[112:127]
    ds_read_b64_tr_b16 v[208:209], v185 offset:0
    ds_read_b64_tr_b16 v[210:211], v185 offset:1024
    s_add_u32 m0, s45, 106496
    s_add_u32 s32, s37, 65536
    buffer_load_dwordx4 v17, s[8:11], s32 offen lds
    v_mfma_f32_32x32x16_bf16 v[128:143], v[232:235], v[220:223], v[128:143]
    ds_read_b64_tr_b16 v[212:213], v186 offset:0
    ds_read_b64_tr_b16 v[214:215], v186 offset:1024
    v_mfma_f32_32x32x16_bf16 v[144:159], v[236:239], v[220:223], v[144:159]
    ds_read_b64_tr_b16 v[216:217], v187 offset:0
    ds_read_b64_tr_b16 v[218:219], v187 offset:1024
    s_waitcnt lgkmcnt(6)
    v_mfma_f32_32x32x16_bf16 v[96:111], v[204:207], v[200:203], v[96:111]
    ds_read_b128 v[220:223], v177 offset:49152
    ds_read_b64_tr_b16 v[224:225], v184 offset:4096
    ds_read_b64_tr_b16 v[226:227], v184 offset:5120
    s_add_u32 m0, s45, 131072
    s_add_u32 s32, s39, 262144
    buffer_load_dwordx4 v18, s[12:15], s32 offen lds
    s_waitcnt lgkmcnt(7)
    v_mfma_f32_32x32x16_bf16 v[112:127], v[208:211], v[200:203], v[112:127]
    ds_read_b64_tr_b16 v[228:229], v185 offset:4096
    ds_read_b64_tr_b16 v[230:231], v185 offset:5120
    s_add_u32 m0, s45, 139264
    s_add_u32 s32, s39, 263168
    buffer_load_dwordx4 v18, s[12:15], s32 offen lds
    s_waitcnt lgkmcnt(7)
    v_mfma_f32_32x32x16_bf16 v[128:143], v[212:215], v[200:203], v[128:143]
    ds_read_b64_tr_b16 v[232:233], v186 offset:4096
    ds_read_b64_tr_b16 v[234:235], v186 offset:5120
    s_waitcnt lgkmcnt(7)
    v_mfma_f32_32x32x16_bf16 v[144:159], v[216:219], v[200:203], v[144:159]
    ds_read_b64_tr_b16 v[236:237], v187 offset:4096
    ds_read_b64_tr_b16 v[238:239], v187 offset:5120
    s_waitcnt lgkmcnt(0)
    s_waitcnt vmcnt(6)
    s_barrier
    v_mfma_f32_32x32x16_bf16 v[96:111], v[224:227], v[220:223], v[96:111]
    ds_read_b128 v[200:203], v178 offset:49152
    ds_read_b64_tr_b16 v[204:205], v184 offset:49152
    ds_read_b64_tr_b16 v[206:207], v184 offset:50176
    s_add_u32 s35, s59, 5
    s_and_b32 s35, s35, 7
    s_lshl_b32 s38, s35, 7
    s_add_u32 s38, s38, s72
    s_lshl_b32 s40, s35, 19
    s_add_u32 s40, s40, s73

    s_add_u32 m0, s45, 32768
    s_add_u32 s32, s40, 0
    buffer_load_dwordx4 v18, s[12:15], s32 offen lds
    v_mfma_f32_32x32x16_bf16 v[112:127], v[228:231], v[220:223], v[112:127]
    ds_read_b64_tr_b16 v[208:209], v185 offset:49152
    ds_read_b64_tr_b16 v[210:211], v185 offset:50176
    s_add_u32 m0, s45, 40960
    s_add_u32 s32, s40, 1024
    buffer_load_dwordx4 v18, s[12:15], s32 offen lds
    v_mfma_f32_32x32x16_bf16 v[128:143], v[232:235], v[220:223], v[128:143]
    ds_read_b64_tr_b16 v[212:213], v186 offset:49152
    ds_read_b64_tr_b16 v[214:215], v186 offset:50176
    v_mfma_f32_32x32x16_bf16 v[144:159], v[236:239], v[220:223], v[144:159]
    ds_read_b64_tr_b16 v[216:217], v187 offset:49152
    ds_read_b64_tr_b16 v[218:219], v187 offset:50176
    s_waitcnt lgkmcnt(6)
    v_mfma_f32_32x32x16_bf16 v[96:111], v[204:207], v[200:203], v[96:111]
    ds_read_b128 v[220:223], v179 offset:49152
    ds_read_b64_tr_b16 v[224:225], v184 offset:53248
    ds_read_b64_tr_b16 v[226:227], v184 offset:54272
    s_waitcnt lgkmcnt(7)
    v_mfma_f32_32x32x16_bf16 v[112:127], v[208:211], v[200:203], v[112:127]
    ds_read_b64_tr_b16 v[228:229], v185 offset:53248
    ds_read_b64_tr_b16 v[230:231], v185 offset:54272
    s_waitcnt lgkmcnt(7)
    v_mfma_f32_32x32x16_bf16 v[128:143], v[212:215], v[200:203], v[128:143]
    ds_read_b64_tr_b16 v[232:233], v186 offset:53248
    ds_read_b64_tr_b16 v[234:235], v186 offset:54272
    s_waitcnt lgkmcnt(7)
    v_mfma_f32_32x32x16_bf16 v[144:159], v[216:219], v[200:203], v[144:159]
    ds_read_b64_tr_b16 v[236:237], v187 offset:53248
    ds_read_b64_tr_b16 v[238:239], v187 offset:54272
    s_waitcnt lgkmcnt(0)
    s_waitcnt vmcnt(4)
    s_barrier
    v_mfma_f32_32x32x16_bf16 v[96:111], v[224:227], v[220:223], v[96:111]
    ds_read_b128 v[200:203], v176 offset:0
    ds_read_b64_tr_b16 v[204:205], v180 offset:16384
    ds_read_b64_tr_b16 v[206:207], v180 offset:17408
    s_add_u32 m0, s45, 147456
    s_add_u32 s32, s38, 0
    buffer_load_dwordx4 v17, s[8:11], s32 offen lds
    v_mfma_f32_32x32x16_bf16 v[112:127], v[228:231], v[220:223], v[112:127]
    ds_read_b64_tr_b16 v[208:209], v181 offset:16384
    ds_read_b64_tr_b16 v[210:211], v181 offset:17408
    s_add_u32 m0, s45, 155648
    s_add_u32 s32, s38, 65536
    buffer_load_dwordx4 v17, s[8:11], s32 offen lds
    v_mfma_f32_32x32x16_bf16 v[128:143], v[232:235], v[220:223], v[128:143]
    ds_read_b64_tr_b16 v[212:213], v182 offset:16384
    ds_read_b64_tr_b16 v[214:215], v182 offset:17408
    v_mfma_f32_32x32x16_bf16 v[144:159], v[236:239], v[220:223], v[144:159]
    ds_read_b64_tr_b16 v[216:217], v183 offset:16384
    ds_read_b64_tr_b16 v[218:219], v183 offset:17408
    s_waitcnt lgkmcnt(6)
    v_mfma_f32_32x32x16_bf16 v[96:111], v[204:207], v[200:203], v[96:111]
    ds_read_b128 v[220:223], v177 offset:0
    ds_read_b64_tr_b16 v[224:225], v180 offset:20480
    ds_read_b64_tr_b16 v[226:227], v180 offset:21504
    s_add_u32 m0, s45, 81920
    s_add_u32 s32, s40, 262144
    buffer_load_dwordx4 v18, s[12:15], s32 offen lds
    s_waitcnt lgkmcnt(7)
    v_mfma_f32_32x32x16_bf16 v[112:127], v[208:211], v[200:203], v[112:127]
    ds_read_b64_tr_b16 v[228:229], v181 offset:20480
    ds_read_b64_tr_b16 v[230:231], v181 offset:21504
    s_add_u32 m0, s45, 90112
    s_add_u32 s32, s40, 263168
    buffer_load_dwordx4 v18, s[12:15], s32 offen lds
    s_waitcnt lgkmcnt(7)
    v_mfma_f32_32x32x16_bf16 v[128:143], v[212:215], v[200:203], v[128:143]
    ds_read_b64_tr_b16 v[232:233], v182 offset:20480
    ds_read_b64_tr_b16 v[234:235], v182 offset:21504
    s_waitcnt lgkmcnt(7)
    v_mfma_f32_32x32x16_bf16 v[144:159], v[216:219], v[200:203], v[144:159]
    ds_read_b64_tr_b16 v[236:237], v183 offset:20480
    ds_read_b64_tr_b16 v[238:239], v183 offset:21504
    s_waitcnt lgkmcnt(0)
    s_waitcnt vmcnt(6)
    s_barrier
    v_mfma_f32_32x32x16_bf16 v[96:111], v[224:227], v[220:223], v[96:111]
    ds_read_b128 v[200:203], v178 offset:0
    ds_read_b64_tr_b16 v[204:205], v180 offset:32768
    ds_read_b64_tr_b16 v[206:207], v180 offset:33792
    s_add_u32 s35, s59, 6
    s_and_b32 s35, s35, 7
    s_lshl_b32 s37, s35, 7
    s_add_u32 s37, s37, s72
    s_lshl_b32 s39, s35, 19
    s_add_u32 s39, s39, s73

    s_add_u32 m0, s45, 114688
    s_add_u32 s32, s39, 0
    buffer_load_dwordx4 v18, s[12:15], s32 offen lds
    v_mfma_f32_32x32x16_bf16 v[112:127], v[228:231], v[220:223], v[112:127]
    ds_read_b64_tr_b16 v[208:209], v181 offset:32768
    ds_read_b64_tr_b16 v[210:211], v181 offset:33792
    s_add_u32 m0, s45, 122880
    s_add_u32 s32, s39, 1024
    buffer_load_dwordx4 v18, s[12:15], s32 offen lds
    v_mfma_f32_32x32x16_bf16 v[128:143], v[232:235], v[220:223], v[128:143]
    ds_read_b64_tr_b16 v[212:213], v182 offset:32768
    ds_read_b64_tr_b16 v[214:215], v182 offset:33792
    v_mfma_f32_32x32x16_bf16 v[144:159], v[236:239], v[220:223], v[144:159]
    ds_read_b64_tr_b16 v[216:217], v183 offset:32768
    ds_read_b64_tr_b16 v[218:219], v183 offset:33792
    s_waitcnt lgkmcnt(6)
    v_mfma_f32_32x32x16_bf16 v[96:111], v[204:207], v[200:203], v[96:111]
    ds_read_b128 v[220:223], v179 offset:0
    ds_read_b64_tr_b16 v[224:225], v180 offset:36864
    ds_read_b64_tr_b16 v[226:227], v180 offset:37888
    s_waitcnt lgkmcnt(7)
    v_mfma_f32_32x32x16_bf16 v[112:127], v[208:211], v[200:203], v[112:127]
    ds_read_b64_tr_b16 v[228:229], v181 offset:36864
    ds_read_b64_tr_b16 v[230:231], v181 offset:37888
    s_waitcnt lgkmcnt(7)
    v_mfma_f32_32x32x16_bf16 v[128:143], v[212:215], v[200:203], v[128:143]
    ds_read_b64_tr_b16 v[232:233], v182 offset:36864
    ds_read_b64_tr_b16 v[234:235], v182 offset:37888
    s_waitcnt lgkmcnt(7)
    v_mfma_f32_32x32x16_bf16 v[144:159], v[216:219], v[200:203], v[144:159]
    ds_read_b64_tr_b16 v[236:237], v183 offset:36864
    ds_read_b64_tr_b16 v[238:239], v183 offset:37888
    s_waitcnt lgkmcnt(0)
    s_waitcnt vmcnt(4)
    s_barrier
    v_mfma_f32_32x32x16_bf16 v[96:111], v[224:227], v[220:223], v[96:111]
    ds_read_b128 v[200:203], v176 offset:49152
    ds_read_b64_tr_b16 v[204:205], v184 offset:0
    ds_read_b64_tr_b16 v[206:207], v184 offset:1024
    s_add_u32 m0, s45, 98304
    s_add_u32 s32, s37, 0
    buffer_load_dwordx4 v17, s[8:11], s32 offen lds
    v_mfma_f32_32x32x16_bf16 v[112:127], v[228:231], v[220:223], v[112:127]
    ds_read_b64_tr_b16 v[208:209], v185 offset:0
    ds_read_b64_tr_b16 v[210:211], v185 offset:1024
    s_add_u32 m0, s45, 106496
    s_add_u32 s32, s37, 65536
    buffer_load_dwordx4 v17, s[8:11], s32 offen lds
    v_mfma_f32_32x32x16_bf16 v[128:143], v[232:235], v[220:223], v[128:143]
    ds_read_b64_tr_b16 v[212:213], v186 offset:0
    ds_read_b64_tr_b16 v[214:215], v186 offset:1024
    v_mfma_f32_32x32x16_bf16 v[144:159], v[236:239], v[220:223], v[144:159]
    ds_read_b64_tr_b16 v[216:217], v187 offset:0
    ds_read_b64_tr_b16 v[218:219], v187 offset:1024
    s_waitcnt lgkmcnt(6)
    v_mfma_f32_32x32x16_bf16 v[96:111], v[204:207], v[200:203], v[96:111]
    ds_read_b128 v[220:223], v177 offset:49152
    ds_read_b64_tr_b16 v[224:225], v184 offset:4096
    ds_read_b64_tr_b16 v[226:227], v184 offset:5120
    s_add_u32 m0, s45, 131072
    s_add_u32 s32, s39, 262144
    buffer_load_dwordx4 v18, s[12:15], s32 offen lds
    s_waitcnt lgkmcnt(7)
    v_mfma_f32_32x32x16_bf16 v[112:127], v[208:211], v[200:203], v[112:127]
    ds_read_b64_tr_b16 v[228:229], v185 offset:4096
    ds_read_b64_tr_b16 v[230:231], v185 offset:5120
    s_add_u32 m0, s45, 139264
    s_add_u32 s32, s39, 263168
    buffer_load_dwordx4 v18, s[12:15], s32 offen lds
    s_waitcnt lgkmcnt(7)
    v_mfma_f32_32x32x16_bf16 v[128:143], v[212:215], v[200:203], v[128:143]
    ds_read_b64_tr_b16 v[232:233], v186 offset:4096
    ds_read_b64_tr_b16 v[234:235], v186 offset:5120
    s_waitcnt lgkmcnt(7)
    v_mfma_f32_32x32x16_bf16 v[144:159], v[216:219], v[200:203], v[144:159]
    ds_read_b64_tr_b16 v[236:237], v187 offset:4096
    ds_read_b64_tr_b16 v[238:239], v187 offset:5120
    s_waitcnt lgkmcnt(0)
    s_waitcnt vmcnt(6)
    s_barrier
    v_mfma_f32_32x32x16_bf16 v[96:111], v[224:227], v[220:223], v[96:111]
    ds_read_b128 v[200:203], v178 offset:49152
    ds_read_b64_tr_b16 v[204:205], v184 offset:49152
    ds_read_b64_tr_b16 v[206:207], v184 offset:50176
    s_add_u32 s35, s59, 7
    s_and_b32 s35, s35, 7
    s_lshl_b32 s38, s35, 7
    s_add_u32 s38, s38, s72
    s_lshl_b32 s40, s35, 19
    s_add_u32 s40, s40, s73

    s_add_u32 m0, s45, 32768
    s_add_u32 s32, s40, 0
    buffer_load_dwordx4 v18, s[12:15], s32 offen lds
    v_mfma_f32_32x32x16_bf16 v[112:127], v[228:231], v[220:223], v[112:127]
    ds_read_b64_tr_b16 v[208:209], v185 offset:49152
    ds_read_b64_tr_b16 v[210:211], v185 offset:50176
    s_add_u32 m0, s45, 40960
    s_add_u32 s32, s40, 1024
    buffer_load_dwordx4 v18, s[12:15], s32 offen lds
    v_mfma_f32_32x32x16_bf16 v[128:143], v[232:235], v[220:223], v[128:143]
    ds_read_b64_tr_b16 v[212:213], v186 offset:49152
    ds_read_b64_tr_b16 v[214:215], v186 offset:50176
    v_mfma_f32_32x32x16_bf16 v[144:159], v[236:239], v[220:223], v[144:159]
    ds_read_b64_tr_b16 v[216:217], v187 offset:49152
    ds_read_b64_tr_b16 v[218:219], v187 offset:50176
    s_waitcnt lgkmcnt(6)
    v_mfma_f32_32x32x16_bf16 v[96:111], v[204:207], v[200:203], v[96:111]
    ds_read_b128 v[220:223], v179 offset:49152
    ds_read_b64_tr_b16 v[224:225], v184 offset:53248
    ds_read_b64_tr_b16 v[226:227], v184 offset:54272
    s_waitcnt lgkmcnt(7)
    v_mfma_f32_32x32x16_bf16 v[112:127], v[208:211], v[200:203], v[112:127]
    ds_read_b64_tr_b16 v[228:229], v185 offset:53248
    ds_read_b64_tr_b16 v[230:231], v185 offset:54272
    s_waitcnt lgkmcnt(7)
    v_mfma_f32_32x32x16_bf16 v[128:143], v[212:215], v[200:203], v[128:143]
    ds_read_b64_tr_b16 v[232:233], v186 offset:53248
    ds_read_b64_tr_b16 v[234:235], v186 offset:54272
    s_waitcnt lgkmcnt(7)
    v_mfma_f32_32x32x16_bf16 v[144:159], v[216:219], v[200:203], v[144:159]
    ds_read_b64_tr_b16 v[236:237], v187 offset:53248
    ds_read_b64_tr_b16 v[238:239], v187 offset:54272
    s_waitcnt lgkmcnt(0)
    s_waitcnt vmcnt(4)
    s_barrier
    v_mfma_f32_32x32x16_bf16 v[96:111], v[224:227], v[220:223], v[96:111]
    ds_read_b128 v[200:203], v176 offset:0
    ds_read_b64_tr_b16 v[204:205], v180 offset:16384
    ds_read_b64_tr_b16 v[206:207], v180 offset:17408
    s_add_u32 m0, s45, 147456
    s_add_u32 s32, s38, 0
    buffer_load_dwordx4 v17, s[8:11], s32 offen lds
    v_mfma_f32_32x32x16_bf16 v[112:127], v[228:231], v[220:223], v[112:127]
    ds_read_b64_tr_b16 v[208:209], v181 offset:16384
    ds_read_b64_tr_b16 v[210:211], v181 offset:17408
    s_add_u32 m0, s45, 155648
    s_add_u32 s32, s38, 65536
    buffer_load_dwordx4 v17, s[8:11], s32 offen lds
    v_mfma_f32_32x32x16_bf16 v[128:143], v[232:235], v[220:223], v[128:143]
    ds_read_b64_tr_b16 v[212:213], v182 offset:16384
    ds_read_b64_tr_b16 v[214:215], v182 offset:17408
    v_mfma_f32_32x32x16_bf16 v[144:159], v[236:239], v[220:223], v[144:159]
    ds_read_b64_tr_b16 v[216:217], v183 offset:16384
    ds_read_b64_tr_b16 v[218:219], v183 offset:17408
    s_waitcnt lgkmcnt(6)
    v_mfma_f32_32x32x16_bf16 v[96:111], v[204:207], v[200:203], v[96:111]
    ds_read_b128 v[220:223], v177 offset:0
    ds_read_b64_tr_b16 v[224:225], v180 offset:20480
    ds_read_b64_tr_b16 v[226:227], v180 offset:21504
    s_add_u32 m0, s45, 81920
    s_add_u32 s32, s40, 262144
    buffer_load_dwordx4 v18, s[12:15], s32 offen lds
    s_waitcnt lgkmcnt(7)
    v_mfma_f32_32x32x16_bf16 v[112:127], v[208:211], v[200:203], v[112:127]
    ds_read_b64_tr_b16 v[228:229], v181 offset:20480
    ds_read_b64_tr_b16 v[230:231], v181 offset:21504
    s_add_u32 m0, s45, 90112
    s_add_u32 s32, s40, 263168
    buffer_load_dwordx4 v18, s[12:15], s32 offen lds
    s_waitcnt lgkmcnt(7)
    v_mfma_f32_32x32x16_bf16 v[128:143], v[212:215], v[200:203], v[128:143]
    ds_read_b64_tr_b16 v[232:233], v182 offset:20480
    ds_read_b64_tr_b16 v[234:235], v182 offset:21504
    s_waitcnt lgkmcnt(7)
    v_mfma_f32_32x32x16_bf16 v[144:159], v[216:219], v[200:203], v[144:159]
    ds_read_b64_tr_b16 v[236:237], v183 offset:20480
    ds_read_b64_tr_b16 v[238:239], v183 offset:21504
    s_waitcnt lgkmcnt(0)
    s_waitcnt vmcnt(6)
    s_barrier
    v_mfma_f32_32x32x16_bf16 v[96:111], v[224:227], v[220:223], v[96:111]
    ds_read_b128 v[200:203], v178 offset:0
    ds_read_b64_tr_b16 v[204:205], v180 offset:32768
    ds_read_b64_tr_b16 v[206:207], v180 offset:33792
    s_add_u32 m0, s58, 0
    s_add_u32 s33, s74, 0
    s_and_b32 s33, s33, 0x1ffff
    s_add_u32 s33, s33, s36
    buffer_load_dwordx4 v14, s[16:19], s33 offen offset:0 nt lds
    v_mfma_f32_32x32x16_bf16 v[112:127], v[228:231], v[220:223], v[112:127]
    ds_read_b64_tr_b16 v[208:209], v181 offset:32768
    ds_read_b64_tr_b16 v[210:211], v181 offset:33792
    s_add_u32 m0, s58, 0
    s_nop 0
    buffer_load_dwordx4 v15, s[16:19], s33 offen offset:1024 nt lds
    v_mfma_f32_32x32x16_bf16 v[128:143], v[232:235], v[220:223], v[128:143]
    ds_read_b64_tr_b16 v[212:213], v182 offset:32768
    ds_read_b64_tr_b16 v[214:215], v182 offset:33792
    s_add_u32 m0, s58, 49152
    s_nop 0
    buffer_load_dwordx4 v16, s[24:27], s33 offen offset:0 nt lds
    v_mfma_f32_32x32x16_bf16 v[144:159], v[236:239], v[220:223], v[144:159]
    ds_read_b64_tr_b16 v[216:217], v183 offset:32768
    ds_read_b64_tr_b16 v[218:219], v183 offset:33792
    s_add_u32 m0, s58, 49152
    s_nop 0
    buffer_load_dwordx4 v16, s[24:27], s33 offen offset:1024 nt lds
    s_waitcnt lgkmcnt(6)
    v_mfma_f32_32x32x16_bf16 v[96:111], v[204:207], v[200:203], v[96:111]
    ds_read_b128 v[220:223], v179 offset:0
    ds_read_b64_tr_b16 v[224:225], v180 offset:36864
    ds_read_b64_tr_b16 v[226:227], v180 offset:37888
    s_waitcnt lgkmcnt(7)
    v_mfma_f32_32x32x16_bf16 v[112:127], v[208:211], v[200:203], v[112:127]
    ds_read_b64_tr_b16 v[228:229], v181 offset:36864
    ds_read_b64_tr_b16 v[230:231], v181 offset:37888
    s_waitcnt lgkmcnt(7)
    v_mfma_f32_32x32x16_bf16 v[128:143], v[212:215], v[200:203], v[128:143]
    ds_read_b64_tr_b16 v[232:233], v182 offset:36864
    ds_read_b64_tr_b16 v[234:235], v182 offset:37888
    s_waitcnt lgkmcnt(7)
    v_mfma_f32_32x32x16_bf16 v[144:159], v[216:219], v[200:203], v[144:159]
    ds_read_b64_tr_b16 v[236:237], v183 offset:36864
    ds_read_b64_tr_b16 v[238:239], v183 offset:37888
    s_waitcnt lgkmcnt(0)
    s_waitcnt vmcnt(6)
    s_barrier
    v_mfma_f32_32x32x16_bf16 v[96:111], v[224:227], v[220:223], v[96:111]
    ds_read_b128 v[200:203], v176 offset:49152
    ds_read_b64_tr_b16 v[204:205], v184 offset:0
    ds_read_b64_tr_b16 v[206:207], v184 offset:1024
    v_mfma_f32_32x32x16_bf16 v[112:127], v[228:231], v[220:223], v[112:127]
    ds_read_b64_tr_b16 v[208:209], v185 offset:0
    ds_read_b64_tr_b16 v[210:211], v185 offset:1024
    v_mfma_f32_32x32x16_bf16 v[128:143], v[232:235], v[220:223], v[128:143]
    ds_read_b64_tr_b16 v[212:213], v186 offset:0
    ds_read_b64_tr_b16 v[214:215], v186 offset:1024
    v_mfma_f32_32x32x16_bf16 v[144:159], v[236:239], v[220:223], v[144:159]
    ds_read_b64_tr_b16 v[216:217], v187 offset:0
    ds_read_b64_tr_b16 v[218:219], v187 offset:1024
    s_waitcnt lgkmcnt(6)
    v_mfma_f32_32x32x16_bf16 v[96:111], v[204:207], v[200:203], v[96:111]
    ds_read_b128 v[220:223], v177 offset:49152
    ds_read_b64_tr_b16 v[224:225], v184 offset:4096
    ds_read_b64_tr_b16 v[226:227], v184 offset:5120
    s_waitcnt lgkmcnt(7)
    v_mfma_f32_32x32x16_bf16 v[112:127], v[208:211], v[200:203], v[112:127]
    ds_read_b64_tr_b16 v[228:229], v185 offset:4096
    ds_read_b64_tr_b16 v[230:231], v185 offset:5120
    s_waitcnt lgkmcnt(7)
    v_mfma_f32_32x32x16_bf16 v[128:143], v[212:215], v[200:203], v[128:143]
    ds_read_b64_tr_b16 v[232:233], v186 offset:4096
    ds_read_b64_tr_b16 v[234:235], v186 offset:5120
    s_waitcnt lgkmcnt(7)
    v_mfma_f32_32x32x16_bf16 v[144:159], v[216:219], v[200:203], v[144:159]
    ds_read_b64_tr_b16 v[236:237], v187 offset:4096
    ds_read_b64_tr_b16 v[238:239], v187 offset:5120
    s_waitcnt lgkmcnt(0)
    s_waitcnt vmcnt(4)
    s_barrier
    v_mfma_f32_32x32x16_bf16 v[96:111], v[224:227], v[220:223], v[96:111]
    ds_read_b128 v[200:203], v178 offset:49152
    ds_read_b64_tr_b16 v[204:205], v184 offset:49152
    ds_read_b64_tr_b16 v[206:207], v184 offset:50176
    v_mfma_f32_32x32x16_bf16 v[112:127], v[228:231], v[220:223], v[112:127]
    ds_read_b64_tr_b16 v[208:209], v185 offset:49152
    ds_read_b64_tr_b16 v[210:211], v185 offset:50176
    v_mfma_f32_32x32x16_bf16 v[128:143], v[232:235], v[220:223], v[128:143]
    ds_read_b64_tr_b16 v[212:213], v186 offset:49152
    ds_read_b64_tr_b16 v[214:215], v186 offset:50176
    v_mfma_f32_32x32x16_bf16 v[144:159], v[236:239], v[220:223], v[144:159]
    ds_read_b64_tr_b16 v[216:217], v187 offset:49152
    ds_read_b64_tr_b16 v[218:219], v187 offset:50176
    s_waitcnt lgkmcnt(6)
    v_mfma_f32_32x32x16_bf16 v[96:111], v[204:207], v[200:203], v[96:111]
    ds_read_b128 v[220:223], v179 offset:49152
    ds_read_b64_tr_b16 v[224:225], v184 offset:53248
    ds_read_b64_tr_b16 v[226:227], v184 offset:54272
    s_waitcnt lgkmcnt(7)
    v_mfma_f32_32x32x16_bf16 v[112:127], v[208:211], v[200:203], v[112:127]
    ds_read_b64_tr_b16 v[228:229], v185 offset:53248
    ds_read_b64_tr_b16 v[230:231], v185 offset:54272
    s_waitcnt lgkmcnt(7)
    v_mfma_f32_32x32x16_bf16 v[128:143], v[212:215], v[200:203], v[128:143]
    ds_read_b64_tr_b16 v[232:233], v186 offset:53248
    ds_read_b64_tr_b16 v[234:235], v186 offset:54272
    s_waitcnt lgkmcnt(7)
    v_mfma_f32_32x32x16_bf16 v[144:159], v[216:219], v[200:203], v[144:159]
    ds_read_b64_tr_b16 v[236:237], v187 offset:53248
    ds_read_b64_tr_b16 v[238:239], v187 offset:54272
    s_waitcnt lgkmcnt(0)
    s_barrier
    v_mfma_f32_32x32x16_bf16 v[96:111], v[224:227], v[220:223], v[96:111]
    s_add_u32 m0, s58, 16384
    s_add_u32 s33, s74, 16384
    s_and_b32 s33, s33, 0x1ffff
    s_add_u32 s33, s33, s36
    buffer_load_dwordx4 v14, s[16:19], s33 offen offset:0 nt lds
    v_mfma_f32_32x32x16_bf16 v[112:127], v[228:231], v[220:223], v[112:127]
    s_add_u32 m0, s58, 16384
    s_nop 0
    buffer_load_dwordx4 v15, s[16:19], s33 offen offset:1024 nt lds
    v_mfma_f32_32x32x16_bf16 v[128:143], v[232:235], v[220:223], v[128:143]
    s_add_u32 m0, s58, 65536
    s_nop 0
    buffer_load_dwordx4 v16, s[24:27], s33 offen offset:0 nt lds
    v_mfma_f32_32x32x16_bf16 v[144:159], v[236:239], v[220:223], v[144:159]
    s_add_u32 m0, s58, 65536
    s_nop 0
    buffer_load_dwordx4 v16, s[24:27], s33 offen offset:1024 nt lds
    s_mov_b32 s12, s100
    s_mov_b32 s13, s101
    s_mov_b32 s14, 0x400000
    s_lshl_b32 s21, s7, 18
    s_add_u32 s8, s84, s21
    s_addc_u32 s9, s85, 0
    s_mov_b32 s10, 0x40000
    s_add_u32 s92, s56, 16777216
    s_addc_u32 s93, s57, 0
    s_mov_b32 s94, 0x1000000
    v_lshrrev_b32 v20, 8, v30
    v_lshrrev_b32 v21, 4, v30
    v_and_b32 v21, 15, v21
    v_lshlrev_b32 v22, 2, v20
    v_xor_b32 v22, v22, v21
    v_lshlrev_b32 v22, 4, v22
    v_lshl_or_b32 v18, v20, 10, v22

    s_nop 7
    s_nop 3
    s_cmp_eq_u32 s4, 0
    s_cbranch_scc0 R1_3
    v_pk_mul_f32 v[96:97], v[96:97], s[44:45] op_sel_hi:[1,0]
    v_pk_mul_f32 v[98:99], v[98:99], s[44:45] op_sel_hi:[1,0]
    v_pk_mul_f32 v[100:101], v[100:101], s[44:45] op_sel_hi:[1,0]
    v_pk_mul_f32 v[102:103], v[102:103], s[44:45] op_sel_hi:[1,0]
    v_pk_mul_f32 v[104:105], v[104:105], s[44:45] op_sel_hi:[1,0]
    v_pk_mul_f32 v[106:107], v[106:107], s[44:45] op_sel_hi:[1,0]
    v_pk_mul_f32 v[108:109], v[108:109], s[44:45] op_sel_hi:[1,0]
    v_pk_mul_f32 v[110:111], v[110:111], s[44:45] op_sel_hi:[1,0]
    v_cvt_pk_bf16_f32 v32, v96, v97
    v_cvt_pk_bf16_f32 v33, v98, v99
    v_cvt_pk_bf16_f32 v34, v100, v101
    v_cvt_pk_bf16_f32 v35, v102, v103
    v_cvt_pk_bf16_f32 v36, v104, v105
    v_cvt_pk_bf16_f32 v37, v106, v107
    v_cvt_pk_bf16_f32 v38, v108, v109
    v_cvt_pk_bf16_f32 v39, v110, v111
    v_pk_mul_f32 v[112:113], v[112:113], s[44:45] op_sel_hi:[1,0]
    v_pk_mul_f32 v[114:115], v[114:115], s[44:45] op_sel_hi:[1,0]
    v_pk_mul_f32 v[116:117], v[116:117], s[44:45] op_sel_hi:[1,0]
    v_pk_mul_f32 v[118:119], v[118:119], s[44:45] op_sel_hi:[1,0]
    v_pk_mul_f32 v[120:121], v[120:121], s[44:45] op_sel_hi:[1,0]
    v_pk_mul_f32 v[122:123], v[122:123], s[44:45] op_sel_hi:[1,0]
    v_pk_mul_f32 v[124:125], v[124:125], s[44:45] op_sel_hi:[1,0]
    v_pk_mul_f32 v[126:127], v[126:127], s[44:45] op_sel_hi:[1,0]
    v_cvt_pk_bf16_f32 v40, v112, v113
    v_cvt_pk_bf16_f32 v41, v114, v115
    v_cvt_pk_bf16_f32 v42, v116, v117
    v_cvt_pk_bf16_f32 v43, v118, v119
    v_cvt_pk_bf16_f32 v44, v120, v121
    v_cvt_pk_bf16_f32 v45, v122, v123
    v_cvt_pk_bf16_f32 v46, v124, v125
    v_cvt_pk_bf16_f32 v47, v126, v127
    v_pk_mul_f32 v[128:129], v[128:129], s[44:45] op_sel_hi:[1,0]
    v_pk_mul_f32 v[130:131], v[130:131], s[44:45] op_sel_hi:[1,0]
    v_pk_mul_f32 v[132:133], v[132:133], s[44:45] op_sel_hi:[1,0]
    v_pk_mul_f32 v[134:135], v[134:135], s[44:45] op_sel_hi:[1,0]
    v_pk_mul_f32 v[136:137], v[136:137], s[44:45] op_sel_hi:[1,0]
    v_pk_mul_f32 v[138:139], v[138:139], s[44:45] op_sel_hi:[1,0]
    v_pk_mul_f32 v[140:141], v[140:141], s[44:45] op_sel_hi:[1,0]
    v_pk_mul_f32 v[142:143], v[142:143], s[44:45] op_sel_hi:[1,0]
    v_cvt_pk_bf16_f32 v48, v128, v129
    v_cvt_pk_bf16_f32 v49, v130, v131
    v_cvt_pk_bf16_f32 v50, v132, v133
    v_cvt_pk_bf16_f32 v51, v134, v135
    v_cvt_pk_bf16_f32 v52, v136, v137
    v_cvt_pk_bf16_f32 v53, v138, v139
    v_cvt_pk_bf16_f32 v54, v140, v141
    v_cvt_pk_bf16_f32 v55, v142, v143
    v_pk_mul_f32 v[144:145], v[144:145], s[44:45] op_sel_hi:[1,0]
    v_pk_mul_f32 v[146:147], v[146:147], s[44:45] op_sel_hi:[1,0]
    v_pk_mul_f32 v[148:149], v[148:149], s[44:45] op_sel_hi:[1,0]
    v_pk_mul_f32 v[150:151], v[150:151], s[44:45] op_sel_hi:[1,0]
    v_pk_mul_f32 v[152:153], v[152:153], s[44:45] op_sel_hi:[1,0]
    v_pk_mul_f32 v[154:155], v[154:155], s[44:45] op_sel_hi:[1,0]
    v_pk_mul_f32 v[156:157], v[156:157], s[44:45] op_sel_hi:[1,0]
    v_pk_mul_f32 v[158:159], v[158:159], s[44:45] op_sel_hi:[1,0]
    v_cvt_pk_bf16_f32 v56, v144, v145
    v_cvt_pk_bf16_f32 v57, v146, v147
    v_cvt_pk_bf16_f32 v58, v148, v149
    v_cvt_pk_bf16_f32 v59, v150, v151
    v_cvt_pk_bf16_f32 v60, v152, v153
    v_cvt_pk_bf16_f32 v61, v154, v155
    v_cvt_pk_bf16_f32 v62, v156, v157
    v_cvt_pk_bf16_f32 v63, v158, v159
    s_nop 0
    ds_write_b128 v31, v[32:35] offset:0
    ds_write_b128 v31, v[36:39] offset:1024
    ds_write_b128 v31, v[40:43] offset:2048
    ds_write_b128 v31, v[44:47] offset:3072
    ds_write_b128 v31, v[48:51] offset:4096
    ds_write_b128 v31, v[52:55] offset:5120
    ds_write_b128 v31, v[56:59] offset:6144
    ds_write_b128 v31, v[60:63] offset:7168
    s_waitcnt lgkmcnt(0)
    s_branch RE_4
R1_3:
    v_pk_mul_f32 v[96:97], v[96:97], s[44:45] op_sel_hi:[1,0]
    v_pk_mul_f32 v[98:99], v[98:99], s[44:45] op_sel_hi:[1,0]
    v_pk_mul_f32 v[100:101], v[100:101], s[44:45] op_sel_hi:[1,0]
    v_pk_mul_f32 v[102:103], v[102:103], s[44:45] op_sel_hi:[1,0]
    v_pk_mul_f32 v[104:105], v[104:105], s[44:45] op_sel_hi:[1,0]
    v_pk_mul_f32 v[106:107], v[106:107], s[44:45] op_sel_hi:[1,0]
    v_pk_mul_f32 v[108:109], v[108:109], s[44:45] op_sel_hi:[1,0]
    v_pk_mul_f32 v[110:111], v[110:111], s[44:45] op_sel_hi:[1,0]
    v_cvt_pk_bf16_f32 v64, v96, v97
    v_cvt_pk_bf16_f32 v65, v98, v99
    v_cvt_pk_bf16_f32 v66, v100, v101
    v_cvt_pk_bf16_f32 v67, v102, v103
    v_cvt_pk_bf16_f32 v68, v104, v105
    v_cvt_pk_bf16_f32 v69, v106, v107
    v_cvt_pk_bf16_f32 v70, v108, v109
    v_cvt_pk_bf16_f32 v71, v110, v111
    v_pk_mul_f32 v[112:113], v[112:113], s[44:45] op_sel_hi:[1,0]
    v_pk_mul_f32 v[114:115], v[114:115], s[44:45] op_sel_hi:[1,0]
    v_pk_mul_f32 v[116:117], v[116:117], s[44:45] op_sel_hi:[1,0]
    v_pk_mul_f32 v[118:119], v[118:119], s[44:45] op_sel_hi:[1,0]
    v_pk_mul_f32 v[120:121], v[120:121], s[44:45] op_sel_hi:[1,0]
    v_pk_mul_f32 v[122:123], v[122:123], s[44:45] op_sel_hi:[1,0]
    v_pk_mul_f32 v[124:125], v[124:125], s[44:45] op_sel_hi:[1,0]
    v_pk_mul_f32 v[126:127], v[126:127], s[44:45] op_sel_hi:[1,0]
    v_cvt_pk_bf16_f32 v72, v112, v113
    v_cvt_pk_bf16_f32 v73, v114, v115
    v_cvt_pk_bf16_f32 v74, v116, v117
    v_cvt_pk_bf16_f32 v75, v118, v119
    v_cvt_pk_bf16_f32 v76, v120, v121
    v_cvt_pk_bf16_f32 v77, v122, v123
    v_cvt_pk_bf16_f32 v78, v124, v125
    v_cvt_pk_bf16_f32 v79, v126, v127
    v_pk_mul_f32 v[128:129], v[128:129], s[44:45] op_sel_hi:[1,0]
    v_pk_mul_f32 v[130:131], v[130:131], s[44:45] op_sel_hi:[1,0]
    v_pk_mul_f32 v[132:133], v[132:133], s[44:45] op_sel_hi:[1,0]
    v_pk_mul_f32 v[134:135], v[134:135], s[44:45] op_sel_hi:[1,0]
    v_pk_mul_f32 v[136:137], v[136:137], s[44:45] op_sel_hi:[1,0]
    v_pk_mul_f32 v[138:139], v[138:139], s[44:45] op_sel_hi:[1,0]
    v_pk_mul_f32 v[140:141], v[140:141], s[44:45] op_sel_hi:[1,0]
    v_pk_mul_f32 v[142:143], v[142:143], s[44:45] op_sel_hi:[1,0]
    v_cvt_pk_bf16_f32 v80, v128, v129
    v_cvt_pk_bf16_f32 v81, v130, v131
    v_cvt_pk_bf16_f32 v82, v132, v133
    v_cvt_pk_bf16_f32 v83, v134, v135
    v_cvt_pk_bf16_f32 v84, v136, v137
    v_cvt_pk_bf16_f32 v85, v138, v139
    v_cvt_pk_bf16_f32 v86, v140, v141
    v_cvt_pk_bf16_f32 v87, v142, v143
    v_pk_mul_f32 v[144:145], v[144:145], s[44:45] op_sel_hi:[1,0]
    v_pk_mul_f32 v[146:147], v[146:147], s[44:45] op_sel_hi:[1,0]
    v_pk_mul_f32 v[148:149], v[148:149], s[44:45] op_sel_hi:[1,0]
    v_pk_mul_f32 v[150:151], v[150:151], s[44:45] op_sel_hi:[1,0]
    v_pk_mul_f32 v[152:153], v[152:153], s[44:45] op_sel_hi:[1,0]
    v_pk_mul_f32 v[154:155], v[154:155], s[44:45] op_sel_hi:[1,0]
    v_pk_mul_f32 v[156:157], v[156:157], s[44:45] op_sel_hi:[1,0]
    v_pk_mul_f32 v[158:159], v[158:159], s[44:45] op_sel_hi:[1,0]
    v_cvt_pk_bf16_f32 v88, v144, v145
    v_cvt_pk_bf16_f32 v89, v146, v147
    v_cvt_pk_bf16_f32 v90, v148, v149
    v_cvt_pk_bf16_f32 v91, v150, v151
    v_cvt_pk_bf16_f32 v92, v152, v153
    v_cvt_pk_bf16_f32 v93, v154, v155
    v_cvt_pk_bf16_f32 v94, v156, v157
    v_cvt_pk_bf16_f32 v95, v158, v159
RE_4:
    s_waitcnt vmcnt(4)
    s_barrier
    s_cmp_eq_u32 s4, 0
    s_cbranch_scc0 R1_5
    s_branch RE_6
R1_5:
    ds_read_b128 v[32:35], v31 offset:0
    ds_read_b128 v[36:39], v31 offset:1024
    ds_read_b128 v[40:43], v31 offset:2048
    ds_read_b128 v[44:47], v31 offset:3072
    ds_read_b128 v[48:51], v31 offset:4096
    ds_read_b128 v[52:55], v31 offset:5120
    ds_read_b128 v[56:59], v31 offset:6144
    ds_read_b128 v[60:63], v31 offset:7168
    s_waitcnt lgkmcnt(0)
RE_6:
    ds_read_b128 v[200:203], v2 offset:0
    ds_read_b128 v[204:207], v3 offset:0
    ds_read_b128 v[208:211], v4 offset:0
    ds_read_b128 v[212:215], v5 offset:0
    s_waitcnt lgkmcnt(3)
    v_mfma_f32_32x32x16_bf16 v[176:191], v[200:203], v[32:35], 0
    ds_read_b64_tr_b16 v[232:233], v10 offset:0
    ds_read_b64_tr_b16 v[234:235], v10 offset:2048
    s_waitcnt lgkmcnt(4)
    v_mfma_f32_32x32x16_bf16 v[176:191], v[204:207], v[36:39], v[176:191]
    ds_read_b128 v[200:203], v6 offset:0
    ds_read_b64_tr_b16 v[236:237], v11 offset:0
    ds_read_b64_tr_b16 v[238:239], v11 offset:2048
    s_add_u32 m0, s58, 32768
    s_add_u32 s33, s74, 32768
    s_and_b32 s33, s33, 0x1ffff
    s_add_u32 s33, s33, s36
    buffer_load_dwordx4 v14, s[16:19], s33 offen offset:0 nt lds
    s_waitcnt lgkmcnt(6)
    v_mfma_f32_32x32x16_bf16 v[176:191], v[208:211], v[40:43], v[176:191]
    ds_read_b128 v[204:207], v7 offset:0
    ds_read_b64_tr_b16 v[240:241], v12 offset:0
    ds_read_b64_tr_b16 v[242:243], v12 offset:2048
    s_waitcnt lgkmcnt(8)
    v_mfma_f32_32x32x16_bf16 v[176:191], v[212:215], v[44:47], v[176:191]
    ds_read_b128 v[208:211], v8 offset:0
    ds_read_b64_tr_b16 v[244:245], v13 offset:0
    ds_read_b64_tr_b16 v[246:247], v13 offset:2048
    s_waitcnt lgkmcnt(8)
    v_mfma_f32_32x32x16_bf16 v[176:191], v[200:203], v[48:51], v[176:191]
    ds_read_b128 v[212:215], v9 offset:0
    s_waitcnt lgkmcnt(6)
    v_mfma_f32_32x32x16_bf16 v[176:191], v[204:207], v[52:55], v[176:191]
    ds_read_b64_tr_b16 v[200:201], v10 offset:4096
    ds_read_b64_tr_b16 v[202:203], v10 offset:6144
    s_add_u32 m0, s58, 32768
    s_nop 0
    buffer_load_dwordx4 v15, s[16:19], s33 offen offset:1024 nt lds
    s_waitcnt lgkmcnt(5)
    v_mfma_f32_32x32x16_bf16 v[176:191], v[208:211], v[56:59], v[176:191]
    ds_read_b64_tr_b16 v[204:205], v11 offset:4096
    ds_read_b64_tr_b16 v[206:207], v11 offset:6144
    s_waitcnt lgkmcnt(4)
    v_mfma_f32_32x32x16_bf16 v[176:191], v[212:215], v[60:63], v[176:191]
    ds_read_b64_tr_b16 v[208:209], v12 offset:4096
    ds_read_b64_tr_b16 v[210:211], v12 offset:6144
    s_nop 1
    ds_read_b64_tr_b16 v[212:213], v13 offset:4096
    ds_read_b64_tr_b16 v[214:215], v13 offset:6144
    s_nop 7
    v_max3_f32 v20, v176, v177, v178
    v_max3_f32 v20, v20, v179, v180
    v_max3_f32 v20, v20, v181, v182
    v_max3_f32 v20, v20, v183, v184
    v_max3_f32 v20, v20, v185, v186
    v_max3_f32 v20, v20, v187, v188
    v_max3_f32 v20, v20, v189, v190
    v_max_f32 v20, v20, v191
    v_mov_b32 v21, v20
    s_nop 1
    v_permlane32_swap_b32 v20, v21
    v_max_f32 v20, v20, v21
    v_sub_f32 v160, 0, v20
    v_sub_f32 v161, 0, v20
    v_sub_f32 v162, 0, v20
    v_sub_f32 v163, 0, v20
    v_sub_f32 v164, 0, v20
    v_sub_f32 v165, 0, v20
    v_sub_f32 v166, 0, v20
    v_sub_f32 v167, 0, v20
    v_sub_f32 v168, 0, v20
    v_sub_f32 v169, 0, v20
    v_sub_f32 v170, 0, v20
    v_sub_f32 v171, 0, v20
    v_sub_f32 v172, 0, v20
    v_sub_f32 v173, 0, v20
    v_sub_f32 v174, 0, v20
    v_sub_f32 v175, 0, v20
    v_sub_f32 v176, v176, v20
    v_sub_f32 v177, v177, v20
    v_sub_f32 v178, v178, v20
    v_sub_f32 v179, v179, v20
    v_sub_f32 v180, v180, v20
    v_sub_f32 v181, v181, v20
    v_sub_f32 v182, v182, v20
    v_sub_f32 v183, v183, v20
    v_sub_f32 v184, v184, v20
    v_sub_f32 v185, v185, v20
    v_sub_f32 v186, v186, v20
    v_sub_f32 v187, v187, v20
    v_sub_f32 v188, v188, v20
    v_sub_f32 v189, v189, v20
    v_sub_f32 v190, v190, v20
    v_sub_f32 v191, v191, v20
L_sm0:
    v_exp_f32 v22, v176
    v_exp_f32 v23, v177
    s_nop 0
    v_add_f32 v20, v22, v23
    v_cvt_pk_bf16_f32 v192, v22, v23
    v_exp_f32 v24, v178
    v_exp_f32 v25, v179
    v_add_f32 v20, v20, v24
    v_add_f32 v20, v20, v25
    v_cvt_pk_bf16_f32 v193, v24, v25
    v_exp_f32 v22, v180
    v_exp_f32 v23, v181
    v_add_f32 v20, v20, v22
    v_add_f32 v20, v20, v23
    v_cvt_pk_bf16_f32 v194, v22, v23
    v_exp_f32 v24, v182
    v_exp_f32 v25, v183
    v_add_f32 v20, v20, v24
    v_add_f32 v20, v20, v25
    v_cvt_pk_bf16_f32 v195, v24, v25
    v_exp_f32 v22, v184
    v_exp_f32 v23, v185
    v_add_f32 v20, v20, v22
    v_add_f32 v20, v20, v23
    v_cvt_pk_bf16_f32 v196, v22, v23
    v_exp_f32 v24, v186
    v_exp_f32 v25, v187
    v_add_f32 v20, v20, v24
    v_add_f32 v20, v20, v25
    v_cvt_pk_bf16_f32 v197, v24, v25
    v_exp_f32 v22, v188
    v_exp_f32 v23, v189
    v_add_f32 v20, v20, v22
    v_add_f32 v20, v20, v23
    v_cvt_pk_bf16_f32 v198, v22, v23
    v_exp_f32 v24, v190
    v_exp_f32 v25, v191
    v_add_f32 v20, v20, v24
    v_add_f32 v20, v20, v25
    v_cvt_pk_bf16_f32 v199, v24, v25
    v_mov_b32 v19, v20
    v_mfma_f32_32x32x16_bf16 v[96:111], v[232:235], v[192:195], 0
    v_mfma_f32_32x32x16_bf16 v[112:127], v[236:239], v[192:195], 0
    s_add_u32 m0, s58, 81920
    s_nop 0
    buffer_load_dwordx4 v16, s[24:27], s33 offen offset:0 nt lds
    v_mfma_f32_32x32x16_bf16 v[128:143], v[240:243], v[192:195], 0
    v_mfma_f32_32x32x16_bf16 v[144:159], v[244:247], v[192:195], 0
    s_waitcnt lgkmcnt(6)
    v_mfma_f32_32x32x16_bf16 v[96:111], v[200:203], v[196:199], v[96:111]
    s_waitcnt lgkmcnt(4)
    v_mfma_f32_32x32x16_bf16 v[112:127], v[204:207], v[196:199], v[112:127]
    s_add_u32 m0, s58, 81920
    s_nop 0
    buffer_load_dwordx4 v16, s[24:27], s33 offen offset:1024 nt lds
    s_waitcnt lgkmcnt(2)
    v_mfma_f32_32x32x16_bf16 v[128:143], v[208:211], v[196:199], v[128:143]
    s_waitcnt lgkmcnt(0)
    v_mfma_f32_32x32x16_bf16 v[144:159], v[212:215], v[196:199], v[144:159]
    s_cmp_eq_u32 s4, 0
    s_cbranch_scc0 R1_7
    s_branch RE_8
R1_7:
    ds_write_b128 v31, v[64:67] offset:32768
    ds_write_b128 v31, v[68:71] offset:33792
    ds_write_b128 v31, v[72:75] offset:34816
    ds_write_b128 v31, v[76:79] offset:35840
    ds_write_b128 v31, v[80:83] offset:36864
    ds_write_b128 v31, v[84:87] offset:37888
    ds_write_b128 v31, v[88:91] offset:38912
    ds_write_b128 v31, v[92:95] offset:39936
RE_8:
    s_waitcnt lgkmcnt(0)
    s_waitcnt vmcnt(4)
    s_barrier
    ds_read_b128 v[200:203], v2 offset:16384
    ds_read_b128 v[204:207], v3 offset:16384
    ds_read_b128 v[208:211], v4 offset:16384
    ds_read_b128 v[212:215], v5 offset:16384
    s_waitcnt lgkmcnt(3)
    v_mfma_f32_32x32x16_bf16 v[176:191], v[200:203], v[32:35], v[160:175]
    ds_read_b64_tr_b16 v[232:233], v10 offset:16384
    ds_read_b64_tr_b16 v[234:235], v10 offset:18432
    s_waitcnt lgkmcnt(4)
    v_mfma_f32_32x32x16_bf16 v[176:191], v[204:207], v[36:39], v[176:191]
    ds_read_b128 v[200:203], v6 offset:16384
    ds_read_b64_tr_b16 v[236:237], v11 offset:16384
    ds_read_b64_tr_b16 v[238:239], v11 offset:18432
    s_add_u32 m0, s58, 0
    s_add_u32 s33, s74, 49152
    s_and_b32 s33, s33, 0x1ffff
    s_add_u32 s33, s33, s36
    buffer_load_dwordx4 v14, s[16:19], s33 offen offset:0 nt lds
    s_waitcnt lgkmcnt(6)
    v_mfma_f32_32x32x16_bf16 v[176:191], v[208:211], v[40:43], v[176:191]
    ds_read_b128 v[204:207], v7 offset:16384
    ds_read_b64_tr_b16 v[240:241], v12 offset:16384
    ds_read_b64_tr_b16 v[242:243], v12 offset:18432
    s_waitcnt lgkmcnt(8)
    v_mfma_f32_32x32x16_bf16 v[176:191], v[212:215], v[44:47], v[176:191]
    ds_read_b128 v[208:211], v8 offset:16384
    ds_read_b64_tr_b16 v[244:245], v13 offset:16384
    ds_read_b64_tr_b16 v[246:247], v13 offset:18432
    s_waitcnt lgkmcnt(8)
    v_mfma_f32_32x32x16_bf16 v[176:191], v[200:203], v[48:51], v[176:191]
    ds_read_b128 v[212:215], v9 offset:16384
    s_waitcnt lgkmcnt(6)
    v_mfma_f32_32x32x16_bf16 v[176:191], v[204:207], v[52:55], v[176:191]
    ds_read_b64_tr_b16 v[200:201], v10 offset:20480
    ds_read_b64_tr_b16 v[202:203], v10 offset:22528
    s_add_u32 m0, s58, 0
    s_nop 0
    buffer_load_dwordx4 v15, s[16:19], s33 offen offset:1024 nt lds
    s_waitcnt lgkmcnt(5)
    v_mfma_f32_32x32x16_bf16 v[176:191], v[208:211], v[56:59], v[176:191]
    ds_read_b64_tr_b16 v[204:205], v11 offset:20480
    ds_read_b64_tr_b16 v[206:207], v11 offset:22528
    s_waitcnt lgkmcnt(4)
    v_mfma_f32_32x32x16_bf16 v[176:191], v[212:215], v[60:63], v[176:191]
    ds_read_b64_tr_b16 v[208:209], v12 offset:20480
    ds_read_b64_tr_b16 v[210:211], v12 offset:22528
    s_nop 1
    ds_read_b64_tr_b16 v[212:213], v13 offset:20480
    ds_read_b64_tr_b16 v[214:215], v13 offset:22528
    s_nop 7
L_sm1:
    v_exp_f32 v22, v176
    v_exp_f32 v23, v177
    s_nop 0
    v_add_f32 v20, v22, v23
    v_cvt_pk_bf16_f32 v192, v22, v23
    v_exp_f32 v24, v178
    v_exp_f32 v25, v179
    v_add_f32 v20, v20, v24
    v_add_f32 v20, v20, v25
    v_cvt_pk_bf16_f32 v193, v24, v25
    v_exp_f32 v22, v180
    v_exp_f32 v23, v181
    v_add_f32 v20, v20, v22
    v_add_f32 v20, v20, v23
    v_cvt_pk_bf16_f32 v194, v22, v23
    v_exp_f32 v24, v182
    v_exp_f32 v25, v183
    v_add_f32 v20, v20, v24
    v_add_f32 v20, v20, v25
    v_cvt_pk_bf16_f32 v195, v24, v25
    v_exp_f32 v22, v184
    v_exp_f32 v23, v185
    v_add_f32 v20, v20, v22
    v_add_f32 v20, v20, v23
    v_cvt_pk_bf16_f32 v196, v22, v23
    v_exp_f32 v24, v186
    v_exp_f32 v25, v187
    v_add_f32 v20, v20, v24
    v_add_f32 v20, v20, v25
    v_cvt_pk_bf16_f32 v197, v24, v25
    v_exp_f32 v22, v188
    v_exp_f32 v23, v189
    v_add_f32 v20, v20, v22
    v_add_f32 v20, v20, v23
    v_cvt_pk_bf16_f32 v198, v22, v23
    v_exp_f32 v24, v190
    v_exp_f32 v25, v191
    v_add_f32 v20, v20, v24
    v_add_f32 v20, v20, v25
    v_cvt_pk_bf16_f32 v199, v24, v25
    v_cmp_lt_f32 vcc, s43, v20
    s_mov_b32 s41, 1
    s_cbranch_vccnz L_rare
    v_add_f32 v19, v19, v20
    v_mfma_f32_32x32x16_bf16 v[96:111], v[232:235], v[192:195], v[96:111]
    v_mfma_f32_32x32x16_bf16 v[112:127], v[236:239], v[192:195], v[112:127]
    s_add_u32 m0, s58, 49152
    s_nop 0
    buffer_load_dwordx4 v16, s[24:27], s33 offen offset:0 nt lds
    v_mfma_f32_32x32x16_bf16 v[128:143], v[240:243], v[192:195], v[128:143]
    v_mfma_f32_32x32x16_bf16 v[144:159], v[244:247], v[192:195], v[144:159]
    s_waitcnt lgkmcnt(6)
    v_mfma_f32_32x32x16_bf16 v[96:111], v[200:203], v[196:199], v[96:111]
    s_waitcnt lgkmcnt(4)
    v_mfma_f32_32x32x16_bf16 v[112:127], v[204:207], v[196:199], v[112:127]
    s_add_u32 m0, s58, 49152
    s_nop 0
    buffer_load_dwordx4 v16, s[24:27], s33 offen offset:1024 nt lds
    s_waitcnt lgkmcnt(2)
    v_mfma_f32_32x32x16_bf16 v[128:143], v[208:211], v[196:199], v[128:143]
    s_waitcnt lgkmcnt(0)
    v_mfma_f32_32x32x16_bf16 v[144:159], v[212:215], v[196:199], v[144:159]
    s_cmp_eq_u32 s4, 0
    s_cbranch_scc0 R1_9
    ds_read_b128 v[64:67], v31 offset:32768
    ds_read_b128 v[68:71], v31 offset:33792
    ds_read_b128 v[72:75], v31 offset:34816
    ds_read_b128 v[76:79], v31 offset:35840
    ds_read_b128 v[80:83], v31 offset:36864
    ds_read_b128 v[84:87], v31 offset:37888
    ds_read_b128 v[88:91], v31 offset:38912
    ds_read_b128 v[92:95], v31 offset:39936
    s_branch RE_10
R1_9:
RE_10:
    s_waitcnt lgkmcnt(0)
    s_waitcnt vmcnt(4)
    s_barrier
    ds_read_b128 v[200:203], v2 offset:32768
    ds_read_b128 v[204:207], v3 offset:32768
    ds_read_b128 v[208:211], v4 offset:32768
    ds_read_b128 v[212:215], v5 offset:32768
    s_waitcnt lgkmcnt(3)
    v_mfma_f32_32x32x16_bf16 v[176:191], v[200:203], v[32:35], v[160:175]
    ds_read_b64_tr_b16 v[232:233], v10 offset:32768
    ds_read_b64_tr_b16 v[234:235], v10 offset:34816
    s_waitcnt lgkmcnt(4)
    v_mfma_f32_32x32x16_bf16 v[176:191], v[204:207], v[36:39], v[176:191]
    ds_read_b128 v[200:203], v6 offset:32768
    ds_read_b64_tr_b16 v[236:237], v11 offset:32768
    ds_read_b64_tr_b16 v[238:239], v11 offset:34816
    s_add_u32 m0, s58, 16384
    s_add_u32 s33, s74, 65536
    s_and_b32 s33, s33, 0x1ffff
    s_add_u32 s33, s33, s36
    buffer_load_dwordx4 v14, s[16:19], s33 offen offset:0 nt lds
    s_waitcnt lgkmcnt(6)
    v_mfma_f32_32x32x16_bf16 v[176:191], v[208:211], v[40:43], v[176:191]
    ds_read_b128 v[204:207], v7 offset:32768
    ds_read_b64_tr_b16 v[240:241], v12 offset:32768
    ds_read_b64_tr_b16 v[242:243], v12 offset:34816
    s_waitcnt lgkmcnt(8)
    v_mfma_f32_32x32x16_bf16 v[176:191], v[212:215], v[44:47], v[176:191]
    ds_read_b128 v[208:211], v8 offset:32768
    ds_read_b64_tr_b16 v[244:245], v13 offset:32768
    ds_read_b64_tr_b16 v[246:247], v13 offset:34816
    s_waitcnt lgkmcnt(8)
    v_mfma_f32_32x32x16_bf16 v[176:191], v[200:203], v[48:51], v[176:191]
    ds_read_b128 v[212:215], v9 offset:32768
    s_waitcnt lgkmcnt(6)
    v_mfma_f32_32x32x16_bf16 v[176:191], v[204:207], v[52:55], v[176:191]
    ds_read_b64_tr_b16 v[200:201], v10 offset:36864
    ds_read_b64_tr_b16 v[202:203], v10 offset:38912
    s_add_u32 m0, s58, 16384
    s_nop 0
    buffer_load_dwordx4 v15, s[16:19], s33 offen offset:1024 nt lds
    s_waitcnt lgkmcnt(5)
    v_mfma_f32_32x32x16_bf16 v[176:191], v[208:211], v[56:59], v[176:191]
    ds_read_b64_tr_b16 v[204:205], v11 offset:36864
    ds_read_b64_tr_b16 v[206:207], v11 offset:38912
    s_waitcnt lgkmcnt(4)
    v_mfma_f32_32x32x16_bf16 v[176:191], v[212:215], v[60:63], v[176:191]
    ds_read_b64_tr_b16 v[208:209], v12 offset:36864
    ds_read_b64_tr_b16 v[210:211], v12 offset:38912
    s_lshl_b32 s32, s82, 3
    s_add_u32 s32, s32, s7
    s_add_u32 s34, s32, 0
    s_and_b32 s34, s34, 3
    s_lshl_b32 s34, s34, 13
    s_lshl_b32 s32, s32, 15
    s_add_u32 s32, s32, s34
    s_lshl_b32 s34, s83, 20
    s_add_u32 s32, s32, s34
    s_add_u32 s32, s32, s45
    buffer_load_dwordx4 v[216:219], v30, s[12:15], s32 offen nt
    buffer_load_dwordx4 v[216:219], v30, s[12:15], s32 offen
    s_nop 1
    ds_read_b64_tr_b16 v[212:213], v13 offset:36864
    ds_read_b64_tr_b16 v[214:215], v13 offset:38912
    s_nop 7
L_sm2:
    v_exp_f32 v22, v176
    v_exp_f32 v23, v177
    s_nop 0
    v_add_f32 v20, v22, v23
    v_cvt_pk_bf16_f32 v192, v22, v23
    v_exp_f32 v24, v178
    v_exp_f32 v25, v179
    v_add_f32 v20, v20, v24
    v_add_f32 v20, v20, v25
    v_cvt_pk_bf16_f32 v193, v24, v25
    v_exp_f32 v22, v180
    v_exp_f32 v23, v181
    v_add_f32 v20, v20, v22
    v_add_f32 v20, v20, v23
    v_cvt_pk_bf16_f32 v194, v22, v23
    v_exp_f32 v24, v182
    v_exp_f32 v25, v183
    v_add_f32 v20, v20, v24
    v_add_f32 v20, v20, v25
    v_cvt_pk_bf16_f32 v195, v24, v25
    v_exp_f32 v22, v184
    v_exp_f32 v23, v185
    v_add_f32 v20, v20, v22
    v_add_f32 v20, v20, v23
    v_cvt_pk_bf16_f32 v196, v22, v23
    v_exp_f32 v24, v186
    v_exp_f32 v25, v187
    v_add_f32 v20, v20, v24
    v_add_f32 v20, v20, v25
    v_cvt_pk_bf16_f32 v197, v24, v25
    v_exp_f32 v22, v188
    v_exp_f32 v23, v189
    v_add_f32 v20, v20, v22
    v_add_f32 v20, v20, v23
    v_cvt_pk_bf16_f32 v198, v22, v23
    v_exp_f32 v24, v190
    v_exp_f32 v25, v191
    v_add_f32 v20, v20, v24
    v_add_f32 v20, v20, v25
    v_cvt_pk_bf16_f32 v199, v24, v25
    v_cmp_lt_f32 vcc, s43, v20
    s_mov_b32 s41, 2
    s_cbranch_vccnz L_rare
    v_add_f32 v19, v19, v20
    v_mfma_f32_32x32x16_bf16 v[96:111], v[232:235], v[192:195], v[96:111]
    v_mfma_f32_32x32x16_bf16 v[112:127], v[236:239], v[192:195], v[112:127]
    s_add_u32 m0, s58, 65536
    s_nop 0
    buffer_load_dwordx4 v16, s[24:27], s33 offen offset:0 nt lds
    v_mfma_f32_32x32x16_bf16 v[128:143], v[240:243], v[192:195], v[128:143]
    v_mfma_f32_32x32x16_bf16 v[144:159], v[244:247], v[192:195], v[144:159]
    s_waitcnt lgkmcnt(6)
    v_mfma_f32_32x32x16_bf16 v[96:111], v[200:203], v[196:199], v[96:111]
    s_waitcnt lgkmcnt(4)
    v_mfma_f32_32x32x16_bf16 v[112:127], v[204:207], v[196:199], v[112:127]
    s_add_u32 m0, s58, 65536
    s_nop 0
    buffer_load_dwordx4 v16, s[24:27], s33 offen offset:1024 nt lds
    s_waitcnt lgkmcnt(2)
    v_mfma_f32_32x32x16_bf16 v[128:143], v[208:211], v[196:199], v[128:143]
    s_waitcnt lgkmcnt(0)
    v_mfma_f32_32x32x16_bf16 v[144:159], v[212:215], v[196:199], v[144:159]
    s_waitcnt lgkmcnt(0)
    s_waitcnt vmcnt(6)
    s_barrier
    ds_read_b128 v[200:203], v2 offset:0
    ds_read_b128 v[204:207], v3 offset:0
    ds_read_b128 v[208:211], v4 offset:0
    ds_read_b128 v[212:215], v5 offset:0
    s_waitcnt lgkmcnt(3)
    v_mfma_f32_32x32x16_bf16 v[176:191], v[200:203], v[32:35], v[160:175]
    ds_read_b64_tr_b16 v[232:233], v10 offset:0
    ds_read_b64_tr_b16 v[234:235], v10 offset:2048
    s_waitcnt lgkmcnt(4)
    v_mfma_f32_32x32x16_bf16 v[176:191], v[204:207], v[36:39], v[176:191]
    ds_read_b128 v[200:203], v6 offset:0
    ds_read_b64_tr_b16 v[236:237], v11 offset:0
    ds_read_b64_tr_b16 v[238:239], v11 offset:2048
    s_add_u32 m0, s58, 32768
    s_add_u32 s33, s74, 81920
    s_and_b32 s33, s33, 0x1ffff
    s_add_u32 s33, s33, s36
    buffer_load_dwordx4 v14, s[16:19], s33 offen offset:0 nt lds
    s_waitcnt lgkmcnt(6)
    v_mfma_f32_32x32x16_bf16 v[176:191], v[208:211], v[40:43], v[176:191]
    ds_read_b128 v[204:207], v7 offset:0
    ds_read_b64_tr_b16 v[240:241], v12 offset:0
    ds_read_b64_tr_b16 v[242:243], v12 offset:2048
    s_waitcnt lgkmcnt(8)
    v_mfma_f32_32x32x16_bf16 v[176:191], v[212:215], v[44:47], v[176:191]
    ds_read_b128 v[208:211], v8 offset:0
    ds_read_b64_tr_b16 v[244:245], v13 offset:0
    ds_read_b64_tr_b16 v[246:247], v13 offset:2048
    s_waitcnt lgkmcnt(8)
    v_mfma_f32_32x32x16_bf16 v[176:191], v[200:203], v[48:51], v[176:191]
    ds_read_b128 v[212:215], v9 offset:0
    s_waitcnt lgkmcnt(6)
    v_mfma_f32_32x32x16_bf16 v[176:191], v[204:207], v[52:55], v[176:191]
    ds_read_b64_tr_b16 v[200:201], v10 offset:4096
    ds_read_b64_tr_b16 v[202:203], v10 offset:6144
    s_add_u32 m0, s58, 32768
    s_nop 0
    buffer_load_dwordx4 v15, s[16:19], s33 offen offset:1024 nt lds
    s_waitcnt lgkmcnt(5)
    v_mfma_f32_32x32x16_bf16 v[176:191], v[208:211], v[56:59], v[176:191]
    ds_read_b64_tr_b16 v[204:205], v11 offset:4096
    ds_read_b64_tr_b16 v[206:207], v11 offset:6144
    s_waitcnt lgkmcnt(4)
    v_mfma_f32_32x32x16_bf16 v[176:191], v[212:215], v[60:63], v[176:191]
    ds_read_b64_tr_b16 v[208:209], v12 offset:4096
    ds_read_b64_tr_b16 v[210:211], v12 offset:6144
    s_lshl_b32 s32, s82, 3
    s_add_u32 s32, s32, s7
    s_add_u32 s34, s32, 1
    s_and_b32 s34, s34, 3
    s_lshl_b32 s34, s34, 13
    s_lshl_b32 s32, s32, 15
    s_add_u32 s32, s32, s34
    s_lshl_b32 s34, s83, 20
    s_add_u32 s32, s32, s34
    s_add_u32 s32, s32, s45
    buffer_load_dwordx4 v[216:219], v30, s[12:15], s32 offen nt
    buffer_load_dwordx4 v[216:219], v30, s[12:15], s32 offen
    s_nop 1
    ds_read_b64_tr_b16 v[212:213], v13 offset:4096
    ds_read_b64_tr_b16 v[214:215], v13 offset:6144
    s_nop 7
L_sm3:
    v_exp_f32 v22, v176
    v_exp_f32 v23, v177
    s_nop 0
    v_add_f32 v20, v22, v23
    v_cvt_pk_bf16_f32 v192, v22, v23
    v_exp_f32 v24, v178
    v_exp_f32 v25, v179
    v_add_f32 v20, v20, v24
    v_add_f32 v20, v20, v25
    v_cvt_pk_bf16_f32 v193, v24, v25
    v_exp_f32 v22, v180
    v_exp_f32 v23, v181
    v_add_f32 v20, v20, v22
    v_add_f32 v20, v20, v23
    v_cvt_pk_bf16_f32 v194, v22, v23
    v_exp_f32 v24, v182
    v_exp_f32 v25, v183
    v_add_f32 v20, v20, v24
    v_add_f32 v20, v20, v25
    v_cvt_pk_bf16_f32 v195, v24, v25
    v_exp_f32 v22, v184
    v_exp_f32 v23, v185
    v_add_f32 v20, v20, v22
    v_add_f32 v20, v20, v23
    v_cvt_pk_bf16_f32 v196, v22, v23
    v_exp_f32 v24, v186
    v_exp_f32 v25, v187
    v_add_f32 v20, v20, v24
    v_add_f32 v20, v20, v25
    v_cvt_pk_bf16_f32 v197, v24, v25
    v_exp_f32 v22, v188
    v_exp_f32 v23, v189
    v_add_f32 v20, v20, v22
    v_add_f32 v20, v20, v23
    v_cvt_pk_bf16_f32 v198, v22, v23
    v_exp_f32 v24, v190
    v_exp_f32 v25, v191
    v_add_f32 v20, v20, v24
    v_add_f32 v20, v20, v25
    v_cvt_pk_bf16_f32 v199, v24, v25
    v_cmp_lt_f32 vcc, s43, v20
    s_mov_b32 s41, 3
    s_cbranch_vccnz L_rare
    v_add_f32 v19, v19, v20
    v_mfma_f32_32x32x16_bf16 v[96:111], v[232:235], v[192:195], v[96:111]
    v_mfma_f32_32x32x16_bf16 v[112:127], v[236:239], v[192:195], v[112:127]
    s_add_u32 m0, s58, 81920
    s_nop 0
    buffer_load_dwordx4 v16, s[24:27], s33 offen offset:0 nt lds
    v_mfma_f32_32x32x16_bf16 v[128:143], v[240:243], v[192:195], v[128:143]
    v_mfma_f32_32x32x16_bf16 v[144:159], v[244:247], v[192:195], v[144:159]
    s_waitcnt lgkmcnt(6)
    v_mfma_f32_32x32x16_bf16 v[96:111], v[200:203], v[196:199], v[96:111]
    s_waitcnt lgkmcnt(4)
    v_mfma_f32_32x32x16_bf16 v[112:127], v[204:207], v[196:199], v[112:127]
    s_add_u32 m0, s58, 81920
    s_nop 0
    buffer_load_dwordx4 v16, s[24:27], s33 offen offset:1024 nt lds
    s_waitcnt lgkmcnt(2)
    v_mfma_f32_32x32x16_bf16 v[128:143], v[208:211], v[196:199], v[128:143]
    s_waitcnt lgkmcnt(0)
    v_mfma_f32_32x32x16_bf16 v[144:159], v[212:215], v[196:199], v[144:159]
    s_waitcnt lgkmcnt(0)
    s_waitcnt vmcnt(6)
    s_barrier
    ds_read_b128 v[200:203], v2 offset:16384
    ds_read_b128 v[204:207], v3 offset:16384
    ds_read_b128 v[208:211], v4 offset:16384
    ds_read_b128 v[212:215], v5 offset:16384
    s_waitcnt lgkmcnt(3)
    v_mfma_f32_32x32x16_bf16 v[176:191], v[200:203], v[32:35], v[160:175]
    ds_read_b64_tr_b16 v[232:233], v10 offset:16384
    ds_read_b64_tr_b16 v[234:235], v10 offset:18432
    s_waitcnt lgkmcnt(4)
    v_mfma_f32_32x32x16_bf16 v[176:191], v[204:207], v[36:39], v[176:191]
    ds_read_b128 v[200:203], v6 offset:16384
    ds_read_b64_tr_b16 v[236:237], v11 offset:16384
    ds_read_b64_tr_b16 v[238:239], v11 offset:18432
    s_add_u32 m0, s58, 0
    s_add_u32 s33, s74, 98304
    s_and_b32 s33, s33, 0x1ffff
    s_add_u32 s33, s33, s36
    buffer_load_dwordx4 v14, s[16:19], s33 offen offset:0 nt lds
    s_waitcnt lgkmcnt(6)
    v_mfma_f32_32x32x16_bf16 v[176:191], v[208:211], v[40:43], v[176:191]
    ds_read_b128 v[204:207], v7 offset:16384
    ds_read_b64_tr_b16 v[240:241], v12 offset:16384
    ds_read_b64_tr_b16 v[242:243], v12 offset:18432
    s_waitcnt lgkmcnt(8)
    v_mfma_f32_32x32x16_bf16 v[176:191], v[212:215], v[44:47], v[176:191]
    ds_read_b128 v[208:211], v8 offset:16384
    ds_read_b64_tr_b16 v[244:245], v13 offset:16384
    ds_read_b64_tr_b16 v[246:247], v13 offset:18432
    s_waitcnt lgkmcnt(8)
    v_mfma_f32_32x32x16_bf16 v[176:191], v[200:203], v[48:51], v[176:191]
    ds_read_b128 v[212:215], v9 offset:16384
    s_waitcnt lgkmcnt(6)
    v_mfma_f32_32x32x16_bf16 v[176:191], v[204:207], v[52:55], v[176:191]
    ds_read_b64_tr_b16 v[200:201], v10 offset:20480
    ds_read_b64_tr_b16 v[202:203], v10 offset:22528
    s_add_u32 m0, s58, 0
    s_nop 0
    buffer_load_dwordx4 v15, s[16:19], s33 offen offset:1024 nt lds
    s_waitcnt lgkmcnt(5)
    v_mfma_f32_32x32x16_bf16 v[176:191], v[208:211], v[56:59], v[176:191]
    ds_read_b64_tr_b16 v[204:205], v11 offset:20480
    ds_read_b64_tr_b16 v[206:207], v11 offset:22528
    s_waitcnt lgkmcnt(4)
    v_mfma_f32_32x32x16_bf16 v[176:191], v[212:215], v[60:63], v[176:191]
    ds_read_b64_tr_b16 v[208:209], v12 offset:20480
    ds_read_b64_tr_b16 v[210:211], v12 offset:22528
    s_lshl_b32 s32, s82, 3
    s_add_u32 s32, s32, s7
    s_add_u32 s34, s32, 2
    s_and_b32 s34, s34, 3
    s_lshl_b32 s34, s34, 13
    s_lshl_b32 s32, s32, 15
    s_add_u32 s32, s32, s34
    s_lshl_b32 s34, s83, 20
    s_add_u32 s32, s32, s34
    s_add_u32 s32, s32, s45
    buffer_load_dwordx4 v[216:219], v30, s[12:15], s32 offen nt
    buffer_load_dwordx4 v[216:219], v30, s[12:15], s32 offen
    s_nop 1
    ds_read_b64_tr_b16 v[212:213], v13 offset:20480
    ds_read_b64_tr_b16 v[214:215], v13 offset:22528
    s_nop 7
L_sm4:
    v_exp_f32 v22, v176
    v_exp_f32 v23, v177
    s_nop 0
    v_add_f32 v20, v22, v23
    v_cvt_pk_bf16_f32 v192, v22, v23
    v_exp_f32 v24, v178
    v_exp_f32 v25, v179
    v_add_f32 v20, v20, v24
    v_add_f32 v20, v20, v25
    v_cvt_pk_bf16_f32 v193, v24, v25
    v_exp_f32 v22, v180
    v_exp_f32 v23, v181
    v_add_f32 v20, v20, v22
    v_add_f32 v20, v20, v23
    v_cvt_pk_bf16_f32 v194, v22, v23
    v_exp_f32 v24, v182
    v_exp_f32 v25, v183
    v_add_f32 v20, v20, v24
    v_add_f32 v20, v20, v25
    v_cvt_pk_bf16_f32 v195, v24, v25
    v_exp_f32 v22, v184
    v_exp_f32 v23, v185
    v_add_f32 v20, v20, v22
    v_add_f32 v20, v20, v23
    v_cvt_pk_bf16_f32 v196, v22, v23
    v_exp_f32 v24, v186
    v_exp_f32 v25, v187
    v_add_f32 v20, v20, v24
    v_add_f32 v20, v20, v25
    v_cvt_pk_bf16_f32 v197, v24, v25
    v_exp_f32 v22, v188
    v_exp_f32 v23, v189
    v_add_f32 v20, v20, v22
    v_add_f32 v20, v20, v23
    v_cvt_pk_bf16_f32 v198, v22, v23
    v_exp_f32 v24, v190
    v_exp_f32 v25, v191
    v_add_f32 v20, v20, v24
    v_add_f32 v20, v20, v25
    v_cvt_pk_bf16_f32 v199, v24, v25
    v_cmp_lt_f32 vcc, s43, v20
    s_mov_b32 s41, 4
    s_cbranch_vccnz L_rare
    v_add_f32 v19, v19, v20
    v_mfma_f32_32x32x16_bf16 v[96:111], v[232:235], v[192:195], v[96:111]
    v_mfma_f32_32x32x16_bf16 v[112:127], v[236:239], v[192:195], v[112:127]
    s_add_u32 m0, s58, 49152
    s_nop 0
    buffer_load_dwordx4 v16, s[24:27], s33 offen offset:0 nt lds
    v_mfma_f32_32x32x16_bf16 v[128:143], v[240:243], v[192:195], v[128:143]
    v_mfma_f32_32x32x16_bf16 v[144:159], v[244:247], v[192:195], v[144:159]
    s_waitcnt lgkmcnt(6)
    v_mfma_f32_32x32x16_bf16 v[96:111], v[200:203], v[196:199], v[96:111]
    s_waitcnt lgkmcnt(4)
    v_mfma_f32_32x32x16_bf16 v[112:127], v[204:207], v[196:199], v[112:127]
    s_add_u32 m0, s58, 49152
    s_nop 0
    buffer_load_dwordx4 v16, s[24:27], s33 offen offset:1024 nt lds
    s_waitcnt lgkmcnt(2)
    v_mfma_f32_32x32x16_bf16 v[128:143], v[208:211], v[196:199], v[128:143]
    s_waitcnt lgkmcnt(0)
    v_mfma_f32_32x32x16_bf16 v[144:159], v[212:215], v[196:199], v[144:159]
    s_waitcnt lgkmcnt(0)
    s_waitcnt vmcnt(6)
    s_barrier
    ds_read_b128 v[200:203], v2 offset:32768
    ds_read_b128 v[204:207], v3 offset:32768
    ds_read_b128 v[208:211], v4 offset:32768
    ds_read_b128 v[212:215], v5 offset:32768
    s_waitcnt lgkmcnt(3)
    v_mfma_f32_32x32x16_bf16 v[176:191], v[200:203], v[32:35], v[160:175]
    ds_read_b64_tr_b16 v[232:233], v10 offset:32768
    ds_read_b64_tr_b16 v[234:235], v10 offset:34816
    s_waitcnt lgkmcnt(4)
    v_mfma_f32_32x32x16_bf16 v[176:191], v[204:207], v[36:39], v[176:191]
    ds_read_b128 v[200:203], v6 offset:32768
    ds_read_b64_tr_b16 v[236:237], v11 offset:32768
    ds_read_b64_tr_b16 v[238:239], v11 offset:34816
    s_add_u32 m0, s58, 16384
    s_add_u32 s33, s74, 114688
    s_and_b32 s33, s33, 0x1ffff
    s_add_u32 s33, s33, s36
    buffer_load_dwordx4 v14, s[16:19], s33 offen offset:0 nt lds
    s_waitcnt lgkmcnt(6)
    v_mfma_f32_32x32x16_bf16 v[176:191], v[208:211], v[40:43], v[176:191]
    ds_read_b128 v[204:207], v7 offset:32768
    ds_read_b64_tr_b16 v[240:241], v12 offset:32768
    ds_read_b64_tr_b16 v[242:243], v12 offset:34816
    s_waitcnt lgkmcnt(8)
    v_mfma_f32_32x32x16_bf16 v[176:191], v[212:215], v[44:47], v[176:191]
    ds_read_b128 v[208:211], v8 offset:32768
    ds_read_b64_tr_b16 v[244:245], v13 offset:32768
    ds_read_b64_tr_b16 v[246:247], v13 offset:34816
    s_waitcnt lgkmcnt(8)
    v_mfma_f32_32x32x16_bf16 v[176:191], v[200:203], v[48:51], v[176:191]
    ds_read_b128 v[212:215], v9 offset:32768
    s_waitcnt lgkmcnt(6)
    v_mfma_f32_32x32x16_bf16 v[176:191], v[204:207], v[52:55], v[176:191]
    ds_read_b64_tr_b16 v[200:201], v10 offset:36864
    ds_read_b64_tr_b16 v[202:203], v10 offset:38912
    s_add_u32 m0, s58, 16384
    s_nop 0
    buffer_load_dwordx4 v15, s[16:19], s33 offen offset:1024 nt lds
    s_waitcnt lgkmcnt(5)
    v_mfma_f32_32x32x16_bf16 v[176:191], v[208:211], v[56:59], v[176:191]
    ds_read_b64_tr_b16 v[204:205], v11 offset:36864
    ds_read_b64_tr_b16 v[206:207], v11 offset:38912
    s_waitcnt lgkmcnt(4)
    v_mfma_f32_32x32x16_bf16 v[176:191], v[212:215], v[60:63], v[176:191]
    ds_read_b64_tr_b16 v[208:209], v12 offset:36864
    ds_read_b64_tr_b16 v[210:211], v12 offset:38912
    s_lshl_b32 s32, s82, 3
    s_add_u32 s32, s32, s7
    s_add_u32 s34, s32, 3
    s_and_b32 s34, s34, 3
    s_lshl_b32 s34, s34, 13
    s_lshl_b32 s32, s32, 15
    s_add_u32 s32, s32, s34
    s_lshl_b32 s34, s83, 20
    s_add_u32 s32, s32, s34
    s_add_u32 s32, s32, s45
    buffer_load_dwordx4 v[216:219], v30, s[12:15], s32 offen nt
    buffer_load_dwordx4 v[216:219], v30, s[12:15], s32 offen
    s_nop 1
    ds_read_b64_tr_b16 v[212:213], v13 offset:36864
    ds_read_b64_tr_b16 v[214:215], v13 offset:38912
    s_nop 7
L_sm5:
    v_exp_f32 v22, v176
    v_exp_f32 v23, v177
    s_nop 0
    v_add_f32 v20, v22, v23
    v_cvt_pk_bf16_f32 v192, v22, v23
    v_exp_f32 v24, v178
    v_exp_f32 v25, v179
    v_add_f32 v20, v20, v24
    v_add_f32 v20, v20, v25
    v_cvt_pk_bf16_f32 v193, v24, v25
    v_exp_f32 v22, v180
    v_exp_f32 v23, v181
    v_add_f32 v20, v20, v22
    v_add_f32 v20, v20, v23
    v_cvt_pk_bf16_f32 v194, v22, v23
    v_exp_f32 v24, v182
    v_exp_f32 v25, v183
    v_add_f32 v20, v20, v24
    v_add_f32 v20, v20, v25
    v_cvt_pk_bf16_f32 v195, v24, v25
    v_exp_f32 v22, v184
    v_exp_f32 v23, v185
    v_add_f32 v20, v20, v22
    v_add_f32 v20, v20, v23
    v_cvt_pk_bf16_f32 v196, v22, v23
    v_exp_f32 v24, v186
    v_exp_f32 v25, v187
    v_add_f32 v20, v20, v24
    v_add_f32 v20, v20, v25
    v_cvt_pk_bf16_f32 v197, v24, v25
    v_exp_f32 v22, v188
    v_exp_f32 v23, v189
    v_add_f32 v20, v20, v22
    v_add_f32 v20, v20, v23
    v_cvt_pk_bf16_f32 v198, v22, v23
    v_exp_f32 v24, v190
    v_exp_f32 v25, v191
    v_add_f32 v20, v20, v24
    v_add_f32 v20, v20, v25
    v_cvt_pk_bf16_f32 v199, v24, v25
    v_cmp_lt_f32 vcc, s43, v20
    s_mov_b32 s41, 5
    s_cbranch_vccnz L_rare
    v_add_f32 v19, v19, v20
    v_mfma_f32_32x32x16_bf16 v[96:111], v[232:235], v[192:195], v[96:111]
    v_mfma_f32_32x32x16_bf16 v[112:127], v[236:239], v[192:195], v[112:127]
    s_add_u32 m0, s58, 65536
    s_nop 0
    buffer_load_dwordx4 v16, s[24:27], s33 offen offset:0 nt lds
    v_mfma_f32_32x32x16_bf16 v[128:143], v[240:243], v[192:195], v[128:143]
    v_mfma_f32_32x32x16_bf16 v[144:159], v[244:247], v[192:195], v[144:159]
    s_waitcnt lgkmcnt(6)
    v_mfma_f32_32x32x16_bf16 v[96:111], v[200:203], v[196:199], v[96:111]
    s_waitcnt lgkmcnt(4)
    v_mfma_f32_32x32x16_bf16 v[112:127], v[204:207], v[196:199], v[112:127]
    s_add_u32 m0, s58, 65536
    s_nop 0
    buffer_load_dwordx4 v16, s[24:27], s33 offen offset:1024 nt lds
    s_waitcnt lgkmcnt(2)
    v_mfma_f32_32x32x16_bf16 v[128:143], v[208:211], v[196:199], v[128:143]
    s_waitcnt lgkmcnt(0)
    v_mfma_f32_32x32x16_bf16 v[144:159], v[212:215], v[196:199], v[144:159]
    s_waitcnt lgkmcnt(0)
    s_waitcnt vmcnt(6)
    s_barrier
    ds_read_b128 v[200:203], v2 offset:0
    ds_read_b128 v[204:207], v3 offset:0
    ds_read_b128 v[208:211], v4 offset:0
    ds_read_b128 v[212:215], v5 offset:0
    s_waitcnt lgkmcnt(3)
    v_mfma_f32_32x32x16_bf16 v[176:191], v[200:203], v[32:35], v[160:175]
    ds_read_b64_tr_b16 v[232:233], v10 offset:0
    ds_read_b64_tr_b16 v[234:235], v10 offset:2048
    s_waitcnt lgkmcnt(4)
    v_mfma_f32_32x32x16_bf16 v[176:191], v[204:207], v[36:39], v[176:191]
    ds_read_b128 v[200:203], v6 offset:0
    ds_read_b64_tr_b16 v[236:237], v11 offset:0
    ds_read_b64_tr_b16 v[238:239], v11 offset:2048
    s_add_u32 m0, s58, 32768
    s_add_u32 s33, s74, 0
    s_and_b32 s33, s33, 0x1ffff
    s_add_u32 s33, s33, 524288
    s_add_u32 s33, s33, s36
    buffer_load_dwordx4 v14, s[16:19], s33 offen offset:0 nt lds
    s_waitcnt lgkmcnt(6)
    v_mfma_f32_32x32x16_bf16 v[176:191], v[208:211], v[40:43], v[176:191]
    ds_read_b128 v[204:207], v7 offset:0
    ds_read_b64_tr_b16 v[240:241], v12 offset:0
    ds_read_b64_tr_b16 v[242:243], v12 offset:2048
    s_waitcnt lgkmcnt(8)
    v_mfma_f32_32x32x16_bf16 v[176:191], v[212:215], v[44:47], v[176:191]
    ds_read_b128 v[208:211], v8 offset:0
    ds_read_b64_tr_b16 v[244:245], v13 offset:0
    ds_read_b64_tr_b16 v[246:247], v13 offset:2048
    s_waitcnt lgkmcnt(8)
    v_mfma_f32_32x32x16_bf16 v[176:191], v[200:203], v[48:51], v[176:191]
    ds_read_b128 v[212:215], v9 offset:0
    s_waitcnt lgkmcnt(6)
    v_mfma_f32_32x32x16_bf16 v[176:191], v[204:207], v[52:55], v[176:191]
    ds_read_b64_tr_b16 v[200:201], v10 offset:4096
    ds_read_b64_tr_b16 v[202:203], v10 offset:6144
    s_add_u32 m0, s58, 32768
    s_nop 0
    buffer_load_dwordx4 v15, s[16:19], s33 offen offset:1024 nt lds
    s_waitcnt lgkmcnt(5)
    v_mfma_f32_32x32x16_bf16 v[176:191], v[208:211], v[56:59], v[176:191]
    ds_read_b64_tr_b16 v[204:205], v11 offset:4096
    ds_read_b64_tr_b16 v[206:207], v11 offset:6144
    s_waitcnt lgkmcnt(4)
    v_mfma_f32_32x32x16_bf16 v[176:191], v[212:215], v[60:63], v[176:191]
    ds_read_b64_tr_b16 v[208:209], v12 offset:4096
    ds_read_b64_tr_b16 v[210:211], v12 offset:6144
    s_nop 1
    ds_read_b64_tr_b16 v[212:213], v13 offset:4096
    ds_read_b64_tr_b16 v[214:215], v13 offset:6144
    s_nop 7
L_sm6:
    v_exp_f32 v22, v176
    v_exp_f32 v23, v177
    s_nop 0
    v_add_f32 v20, v22, v23
    v_cvt_pk_bf16_f32 v192, v22, v23
    v_exp_f32 v24, v178
    v_exp_f32 v25, v179
    v_add_f32 v20, v20, v24
    v_add_f32 v20, v20, v25
    v_cvt_pk_bf16_f32 v193, v24, v25
    v_exp_f32 v22, v180
    v_exp_f32 v23, v181
    v_add_f32 v20, v20, v22
    v_add_f32 v20, v20, v23
    v_cvt_pk_bf16_f32 v194, v22, v23
    v_exp_f32 v24, v182
    v_exp_f32 v25, v183
    v_add_f32 v20, v20, v24
    v_add_f32 v20, v20, v25
    v_cvt_pk_bf16_f32 v195, v24, v25
    v_exp_f32 v22, v184
    v_exp_f32 v23, v185
    v_add_f32 v20, v20, v22
    v_add_f32 v20, v20, v23
    v_cvt_pk_bf16_f32 v196, v22, v23
    v_exp_f32 v24, v186
    v_exp_f32 v25, v187
    v_add_f32 v20, v20, v24
    v_add_f32 v20, v20, v25
    v_cvt_pk_bf16_f32 v197, v24, v25
    v_exp_f32 v22, v188
    v_exp_f32 v23, v189
    v_add_f32 v20, v20, v22
    v_add_f32 v20, v20, v23
    v_cvt_pk_bf16_f32 v198, v22, v23
    v_exp_f32 v24, v190
    v_exp_f32 v25, v191
    v_add_f32 v20, v20, v24
    v_add_f32 v20, v20, v25
    v_cvt_pk_bf16_f32 v199, v24, v25
    v_cmp_lt_f32 vcc, s43, v20
    s_mov_b32 s41, 6
    s_cbranch_vccnz L_rare
    v_add_f32 v19, v19, v20
    v_mfma_f32_32x32x16_bf16 v[96:111], v[232:235], v[192:195], v[96:111]
    v_mfma_f32_32x32x16_bf16 v[112:127], v[236:239], v[192:195], v[112:127]
    s_add_u32 m0, s58, 81920
    s_nop 0
    buffer_load_dwordx4 v16, s[24:27], s33 offen offset:0 nt lds
    v_mfma_f32_32x32x16_bf16 v[128:143], v[240:243], v[192:195], v[128:143]
    v_mfma_f32_32x32x16_bf16 v[144:159], v[244:247], v[192:195], v[144:159]
    s_waitcnt lgkmcnt(6)
    v_mfma_f32_32x32x16_bf16 v[96:111], v[200:203], v[196:199], v[96:111]
    s_waitcnt lgkmcnt(4)
    v_mfma_f32_32x32x16_bf16 v[112:127], v[204:207], v[196:199], v[112:127]
    s_add_u32 m0, s58, 81920
    s_nop 0
    buffer_load_dwordx4 v16, s[24:27], s33 offen offset:1024 nt lds
    s_waitcnt lgkmcnt(2)
    v_mfma_f32_32x32x16_bf16 v[128:143], v[208:211], v[196:199], v[128:143]
    s_waitcnt lgkmcnt(0)
    v_mfma_f32_32x32x16_bf16 v[144:159], v[212:215], v[196:199], v[144:159]
    s_waitcnt lgkmcnt(0)
    s_waitcnt vmcnt(4)
    s_barrier
    ds_read_b128 v[200:203], v2 offset:16384
    ds_read_b128 v[204:207], v3 offset:16384
    ds_read_b128 v[208:211], v4 offset:16384
    ds_read_b128 v[212:215], v5 offset:16384
    s_waitcnt lgkmcnt(3)
    v_mfma_f32_32x32x16_bf16 v[176:191], v[200:203], v[32:35], v[160:175]
    ds_read_b64_tr_b16 v[232:233], v10 offset:16384
    ds_read_b64_tr_b16 v[234:235], v10 offset:18432
    s_waitcnt lgkmcnt(4)
    v_mfma_f32_32x32x16_bf16 v[176:191], v[204:207], v[36:39], v[176:191]
    ds_read_b128 v[200:203], v6 offset:16384
    ds_read_b64_tr_b16 v[236:237], v11 offset:16384
    ds_read_b64_tr_b16 v[238:239], v11 offset:18432
    s_add_u32 m0, s58, 0
    s_add_u32 s33, s74, 16384
    s_and_b32 s33, s33, 0x1ffff
    s_add_u32 s33, s33, 524288
    s_add_u32 s33, s33, s36
    buffer_load_dwordx4 v14, s[16:19], s33 offen offset:0 nt lds
    s_waitcnt lgkmcnt(6)
    v_mfma_f32_32x32x16_bf16 v[176:191], v[208:211], v[40:43], v[176:191]
    ds_read_b128 v[204:207], v7 offset:16384
    ds_read_b64_tr_b16 v[240:241], v12 offset:16384
    ds_read_b64_tr_b16 v[242:243], v12 offset:18432
    s_waitcnt lgkmcnt(8)
    v_mfma_f32_32x32x16_bf16 v[176:191], v[212:215], v[44:47], v[176:191]
    ds_read_b128 v[208:211], v8 offset:16384
    ds_read_b64_tr_b16 v[244:245], v13 offset:16384
    ds_read_b64_tr_b16 v[246:247], v13 offset:18432
    s_waitcnt lgkmcnt(8)
    v_mfma_f32_32x32x16_bf16 v[176:191], v[200:203], v[48:51], v[176:191]
    ds_read_b128 v[212:215], v9 offset:16384
    s_waitcnt lgkmcnt(6)
    v_mfma_f32_32x32x16_bf16 v[176:191], v[204:207], v[52:55], v[176:191]
    ds_read_b64_tr_b16 v[200:201], v10 offset:20480
    ds_read_b64_tr_b16 v[202:203], v10 offset:22528
    s_add_u32 m0, s58, 0
    s_nop 0
    buffer_load_dwordx4 v15, s[16:19], s33 offen offset:1024 nt lds
    s_waitcnt lgkmcnt(5)
    v_mfma_f32_32x32x16_bf16 v[176:191], v[208:211], v[56:59], v[176:191]
    ds_read_b64_tr_b16 v[204:205], v11 offset:20480
    ds_read_b64_tr_b16 v[206:207], v11 offset:22528
    s_waitcnt lgkmcnt(4)
    v_mfma_f32_32x32x16_bf16 v[176:191], v[212:215], v[60:63], v[176:191]
    ds_read_b64_tr_b16 v[208:209], v12 offset:20480
    ds_read_b64_tr_b16 v[210:211], v12 offset:22528
    s_nop 1
    ds_read_b64_tr_b16 v[212:213], v13 offset:20480
    ds_read_b64_tr_b16 v[214:215], v13 offset:22528
    s_nop 7
L_sm7:
    v_exp_f32 v22, v176
    v_exp_f32 v23, v177
    s_nop 0
    v_add_f32 v20, v22, v23
    v_cvt_pk_bf16_f32 v192, v22, v23
    v_exp_f32 v24, v178
    v_exp_f32 v25, v179
    v_add_f32 v20, v20, v24
    v_add_f32 v20, v20, v25
    v_cvt_pk_bf16_f32 v193, v24, v25
    v_exp_f32 v22, v180
    v_exp_f32 v23, v181
    v_add_f32 v20, v20, v22
    v_add_f32 v20, v20, v23
    v_cvt_pk_bf16_f32 v194, v22, v23
    v_exp_f32 v24, v182
    v_exp_f32 v25, v183
    v_add_f32 v20, v20, v24
    v_add_f32 v20, v20, v25
    v_cvt_pk_bf16_f32 v195, v24, v25
    v_exp_f32 v22, v184
    v_exp_f32 v23, v185
    v_add_f32 v20, v20, v22
    v_add_f32 v20, v20, v23
    v_cvt_pk_bf16_f32 v196, v22, v23
    v_exp_f32 v24, v186
    v_exp_f32 v25, v187
    v_add_f32 v20, v20, v24
    v_add_f32 v20, v20, v25
    v_cvt_pk_bf16_f32 v197, v24, v25
    v_exp_f32 v22, v188
    v_exp_f32 v23, v189
    v_add_f32 v20, v20, v22
    v_add_f32 v20, v20, v23
    v_cvt_pk_bf16_f32 v198, v22, v23
    v_exp_f32 v24, v190
    v_exp_f32 v25, v191
    v_add_f32 v20, v20, v24
    v_add_f32 v20, v20, v25
    v_cvt_pk_bf16_f32 v199, v24, v25
    v_cmp_lt_f32 vcc, s43, v20
    s_mov_b32 s41, 7
    s_cbranch_vccnz L_rare
    v_add_f32 v19, v19, v20
    v_mov_b32 v21, v19
    s_nop 1
    v_permlane32_swap_b32 v19, v21
    v_add_f32 v19, v19, v21
    ds_write_b32 v29, v160
    ds_write_b32 v29, v19 offset:4
    v_mfma_f32_32x32x16_bf16 v[96:111], v[232:235], v[192:195], v[96:111]
    v_mfma_f32_32x32x16_bf16 v[112:127], v[236:239], v[192:195], v[112:127]
    s_add_u32 m0, s58, 49152
    s_nop 0
    buffer_load_dwordx4 v16, s[24:27], s33 offen offset:0 nt lds
    v_mfma_f32_32x32x16_bf16 v[128:143], v[240:243], v[192:195], v[128:143]
    v_mfma_f32_32x32x16_bf16 v[144:159], v[244:247], v[192:195], v[144:159]
    s_waitcnt lgkmcnt(8)
    v_mfma_f32_32x32x16_bf16 v[96:111], v[200:203], v[196:199], v[96:111]
    s_waitcnt lgkmcnt(6)
    v_mfma_f32_32x32x16_bf16 v[112:127], v[204:207], v[196:199], v[112:127]
    s_add_u32 m0, s58, 49152
    s_nop 0
    buffer_load_dwordx4 v16, s[24:27], s33 offen offset:1024 nt lds
    s_waitcnt lgkmcnt(4)
    v_mfma_f32_32x32x16_bf16 v[128:143], v[208:211], v[196:199], v[128:143]
    s_waitcnt lgkmcnt(2)
    v_mfma_f32_32x32x16_bf16 v[144:159], v[212:215], v[196:199], v[144:159]
    s_waitcnt lgkmcnt(0)
    s_waitcnt vmcnt(4)
    s_barrier
    ds_read_b64 v[20:21], v28
    s_add_u32 m0, s58, 16384
    s_add_u32 s33, s74, 32768
    s_and_b32 s33, s33, 0x1ffff
    s_add_u32 s33, s33, 524288
    s_add_u32 s33, s33, s36
    buffer_load_dwordx4 v14, s[16:19], s33 offen offset:0 nt lds
    s_waitcnt lgkmcnt(0)
    v_min_f32 v22, v160, v20
    v_sub_f32 v23, v22, v160
    v_sub_f32 v24, v22, v20
    v_exp_f32 v23, v23
    v_exp_f32 v24, v24
    s_nop 0
    v_mul_f32 v25, v19, v23
    v_fma_f32 v25, v21, v24, v25
    v_rcp_f32 v25, v25
    s_nop 0
    v_mul_f32 v24, v23, v25
    v_mul_f32 v25, v23, v25

    s_cmp_eq_u32 s4, 0
    s_cbranch_scc0 R1_11
    v_pk_mul_f32 v[128:129], v[128:129], v[24:25]
    v_pk_mul_f32 v[130:131], v[130:131], v[24:25]
    ds_write_b128 v28, v[128:131] offset:0
    v_pk_mul_f32 v[132:133], v[132:133], v[24:25]
    v_pk_mul_f32 v[134:135], v[134:135], v[24:25]
    ds_write_b128 v28, v[132:135] offset:1024
    v_pk_mul_f32 v[136:137], v[136:137], v[24:25]
    v_pk_mul_f32 v[138:139], v[138:139], v[24:25]
    ds_write_b128 v28, v[136:139] offset:2048
    v_pk_mul_f32 v[140:141], v[140:141], v[24:25]
    v_pk_mul_f32 v[142:143], v[142:143], v[24:25]
    ds_write_b128 v28, v[140:143] offset:3072
    v_pk_mul_f32 v[144:145], v[144:145], v[24:25]
    v_pk_mul_f32 v[146:147], v[146:147], v[24:25]
    ds_write_b128 v28, v[144:147] offset:4096
    v_pk_mul_f32 v[148:149], v[148:149], v[24:25]
    v_pk_mul_f32 v[150:151], v[150:151], v[24:25]
    ds_write_b128 v28, v[148:151] offset:5120
    v_pk_mul_f32 v[152:153], v[152:153], v[24:25]
    v_pk_mul_f32 v[154:155], v[154:155], v[24:25]
    ds_write_b128 v28, v[152:155] offset:6144
    v_pk_mul_f32 v[156:157], v[156:157], v[24:25]
    v_pk_mul_f32 v[158:159], v[158:159], v[24:25]
    ds_write_b128 v28, v[156:159] offset:7168
    s_waitcnt lgkmcnt(0)
    s_barrier
    ds_read_b128 v[200:203], v29 offset:0
    ds_read_b128 v[204:207], v29 offset:1024
    ds_read_b128 v[208:211], v29 offset:2048
    ds_read_b128 v[212:215], v29 offset:3072
    ds_read_b128 v[232:235], v29 offset:4096
    ds_read_b128 v[236:239], v29 offset:5120
    ds_read_b128 v[240:243], v29 offset:6144
    ds_read_b128 v[244:247], v29 offset:7168
    s_waitcnt lgkmcnt(7)
    v_pk_fma_f32 v[96:97], v[96:97], v[24:25], v[200:201]
    v_pk_fma_f32 v[98:99], v[98:99], v[24:25], v[202:203]
    v_cvt_pk_bf16_f32 v216, v96, v97
    v_cvt_pk_bf16_f32 v217, v98, v99
    s_waitcnt lgkmcnt(6)
    v_pk_fma_f32 v[100:101], v[100:101], v[24:25], v[204:205]
    v_pk_fma_f32 v[102:103], v[102:103], v[24:25], v[206:207]
    v_cvt_pk_bf16_f32 v218, v100, v101
    v_cvt_pk_bf16_f32 v219, v102, v103
    s_waitcnt lgkmcnt(5)
    v_pk_fma_f32 v[104:105], v[104:105], v[24:25], v[208:209]
    v_pk_fma_f32 v[106:107], v[106:107], v[24:25], v[210:211]
    v_cvt_pk_bf16_f32 v220, v104, v105
    v_cvt_pk_bf16_f32 v221, v106, v107
    s_waitcnt lgkmcnt(4)
    v_pk_fma_f32 v[108:109], v[108:109], v[24:25], v[212:213]
    v_pk_fma_f32 v[110:111], v[110:111], v[24:25], v[214:215]
    v_cvt_pk_bf16_f32 v222, v108, v109
    v_cvt_pk_bf16_f32 v223, v110, v111
    s_add_u32 s34, s42, 0
    buffer_store_dwordx4 v[216:219], v30, s[28:31], s34 offen sc1
    s_add_u32 s34, s42, 1024
    buffer_store_dwordx4 v[220:223], v30, s[28:31], s34 offen sc1
    s_waitcnt lgkmcnt(3)
    v_pk_fma_f32 v[112:113], v[112:113], v[24:25], v[232:233]
    v_pk_fma_f32 v[114:115], v[114:115], v[24:25], v[234:235]
    v_cvt_pk_bf16_f32 v224, v112, v113
    v_cvt_pk_bf16_f32 v225, v114, v115
    s_waitcnt lgkmcnt(2)
    v_pk_fma_f32 v[116:117], v[116:117], v[24:25], v[236:237]
    v_pk_fma_f32 v[118:119], v[118:119], v[24:25], v[238:239]
    v_cvt_pk_bf16_f32 v226, v116, v117
    v_cvt_pk_bf16_f32 v227, v118, v119
    s_waitcnt lgkmcnt(1)
    v_pk_fma_f32 v[120:121], v[120:121], v[24:25], v[240:241]
    v_pk_fma_f32 v[122:123], v[122:123], v[24:25], v[242:243]
    v_cvt_pk_bf16_f32 v228, v120, v121
    v_cvt_pk_bf16_f32 v229, v122, v123
    s_waitcnt lgkmcnt(0)
    v_pk_fma_f32 v[124:125], v[124:125], v[24:25], v[244:245]
    v_pk_fma_f32 v[126:127], v[126:127], v[24:25], v[246:247]
    v_cvt_pk_bf16_f32 v230, v124, v125
    v_cvt_pk_bf16_f32 v231, v126, v127
    s_add_u32 s34, s42, 2048
    buffer_store_dwordx4 v[224:227], v30, s[28:31], s34 offen sc1
    s_add_u32 s34, s42, 3072
    buffer_store_dwordx4 v[228:231], v30, s[28:31], s34 offen sc1
    s_branch RE_12
R1_11:
    v_pk_mul_f32 v[96:97], v[96:97], v[24:25]
    v_pk_mul_f32 v[98:99], v[98:99], v[24:25]
    ds_write_b128 v28, v[96:99] offset:0
    v_pk_mul_f32 v[100:101], v[100:101], v[24:25]
    v_pk_mul_f32 v[102:103], v[102:103], v[24:25]
    ds_write_b128 v28, v[100:103] offset:1024
    v_pk_mul_f32 v[104:105], v[104:105], v[24:25]
    v_pk_mul_f32 v[106:107], v[106:107], v[24:25]
    ds_write_b128 v28, v[104:107] offset:2048
    v_pk_mul_f32 v[108:109], v[108:109], v[24:25]
    v_pk_mul_f32 v[110:111], v[110:111], v[24:25]
    ds_write_b128 v28, v[108:111] offset:3072
    v_pk_mul_f32 v[112:113], v[112:113], v[24:25]
    v_pk_mul_f32 v[114:115], v[114:115], v[24:25]
    ds_write_b128 v28, v[112:115] offset:4096
    v_pk_mul_f32 v[116:117], v[116:117], v[24:25]
    v_pk_mul_f32 v[118:119], v[118:119], v[24:25]
    ds_write_b128 v28, v[116:119] offset:5120
    v_pk_mul_f32 v[120:121], v[120:121], v[24:25]
    v_pk_mul_f32 v[122:123], v[122:123], v[24:25]
    ds_write_b128 v28, v[120:123] offset:6144
    v_pk_mul_f32 v[124:125], v[124:125], v[24:25]
    v_pk_mul_f32 v[126:127], v[126:127], v[24:25]
    ds_write_b128 v28, v[124:127] offset:7168
    s_waitcnt lgkmcnt(0)
    s_barrier
    ds_read_b128 v[200:203], v29 offset:0
    ds_read_b128 v[204:207], v29 offset:1024
    ds_read_b128 v[208:211], v29 offset:2048
    ds_read_b128 v[212:215], v29 offset:3072
    ds_read_b128 v[232:235], v29 offset:4096
    ds_read_b128 v[236:239], v29 offset:5120
    ds_read_b128 v[240:243], v29 offset:6144
    ds_read_b128 v[244:247], v29 offset:7168
    s_waitcnt lgkmcnt(7)
    v_pk_fma_f32 v[128:129], v[128:129], v[24:25], v[200:201]
    v_pk_fma_f32 v[130:131], v[130:131], v[24:25], v[202:203]
    v_cvt_pk_bf16_f32 v216, v128, v129
    v_cvt_pk_bf16_f32 v217, v130, v131
    s_waitcnt lgkmcnt(6)
    v_pk_fma_f32 v[132:133], v[132:133], v[24:25], v[204:205]
    v_pk_fma_f32 v[134:135], v[134:135], v[24:25], v[206:207]
    v_cvt_pk_bf16_f32 v218, v132, v133
    v_cvt_pk_bf16_f32 v219, v134, v135
    s_waitcnt lgkmcnt(5)
    v_pk_fma_f32 v[136:137], v[136:137], v[24:25], v[208:209]
    v_pk_fma_f32 v[138:139], v[138:139], v[24:25], v[210:211]
    v_cvt_pk_bf16_f32 v220, v136, v137
    v_cvt_pk_bf16_f32 v221, v138, v139
    s_waitcnt lgkmcnt(4)
    v_pk_fma_f32 v[140:141], v[140:141], v[24:25], v[212:213]
    v_pk_fma_f32 v[142:143], v[142:143], v[24:25], v[214:215]
    v_cvt_pk_bf16_f32 v222, v140, v141
    v_cvt_pk_bf16_f32 v223, v142, v143
    s_add_u32 s34, s42, 4096
    buffer_store_dwordx4 v[216:219], v30, s[28:31], s34 offen sc1
    s_add_u32 s34, s42, 5120
    buffer_store_dwordx4 v[220:223], v30, s[28:31], s34 offen sc1
    s_waitcnt lgkmcnt(3)
    v_pk_fma_f32 v[144:145], v[144:145], v[24:25], v[232:233]
    v_pk_fma_f32 v[146:147], v[146:147], v[24:25], v[234:235]
    v_cvt_pk_bf16_f32 v224, v144, v145
    v_cvt_pk_bf16_f32 v225, v146, v147
    s_waitcnt lgkmcnt(2)
    v_pk_fma_f32 v[148:149], v[148:149], v[24:25], v[236:237]
    v_pk_fma_f32 v[150:151], v[150:151], v[24:25], v[238:239]
    v_cvt_pk_bf16_f32 v226, v148, v149
    v_cvt_pk_bf16_f32 v227, v150, v151
    s_waitcnt lgkmcnt(1)
    v_pk_fma_f32 v[152:153], v[152:153], v[24:25], v[240:241]
    v_pk_fma_f32 v[154:155], v[154:155], v[24:25], v[242:243]
    v_cvt_pk_bf16_f32 v228, v152, v153
    v_cvt_pk_bf16_f32 v229, v154, v155
    s_waitcnt lgkmcnt(0)
    v_pk_fma_f32 v[156:157], v[156:157], v[24:25], v[244:245]
    v_pk_fma_f32 v[158:159], v[158:159], v[24:25], v[246:247]
    v_cvt_pk_bf16_f32 v230, v156, v157
    v_cvt_pk_bf16_f32 v231, v158, v159
    s_add_u32 s34, s42, 6144
    buffer_store_dwordx4 v[224:227], v30, s[28:31], s34 offen sc1
    s_add_u32 s34, s42, 7168
    buffer_store_dwordx4 v[228:231], v30, s[28:31], s34 offen sc1
RE_12:
    s_nop 1
    ds_read_b128 v[200:203], v2 offset:32768
    ds_read_b128 v[204:207], v3 offset:32768
    ds_read_b128 v[208:211], v4 offset:32768
    ds_read_b128 v[212:215], v5 offset:32768
    s_waitcnt lgkmcnt(3)
    v_mfma_f32_32x32x16_bf16 v[176:191], v[200:203], v[64:67], 0
    ds_read_b64_tr_b16 v[232:233], v10 offset:32768
    ds_read_b64_tr_b16 v[234:235], v10 offset:34816
    s_waitcnt lgkmcnt(4)
    v_mfma_f32_32x32x16_bf16 v[176:191], v[204:207], v[68:71], v[176:191]
    ds_read_b128 v[200:203], v6 offset:32768
    ds_read_b64_tr_b16 v[236:237], v11 offset:32768
    ds_read_b64_tr_b16 v[238:239], v11 offset:34816
    s_waitcnt lgkmcnt(6)
    v_mfma_f32_32x32x16_bf16 v[176:191], v[208:211], v[72:75], v[176:191]
    ds_read_b128 v[204:207], v7 offset:32768
    ds_read_b64_tr_b16 v[240:241], v12 offset:32768
    ds_read_b64_tr_b16 v[242:243], v12 offset:34816
    s_waitcnt lgkmcnt(8)
    v_mfma_f32_32x32x16_bf16 v[176:191], v[212:215], v[76:79], v[176:191]
    ds_read_b128 v[208:211], v8 offset:32768
    ds_read_b64_tr_b16 v[244:245], v13 offset:32768
    ds_read_b64_tr_b16 v[246:247], v13 offset:34816
    s_waitcnt lgkmcnt(8)
    v_mfma_f32_32x32x16_bf16 v[176:191], v[200:203], v[80:83], v[176:191]
    ds_read_b128 v[212:215], v9 offset:32768
    s_waitcnt lgkmcnt(6)
    v_mfma_f32_32x32x16_bf16 v[176:191], v[204:207], v[84:87], v[176:191]
    ds_read_b64_tr_b16 v[200:201], v10 offset:36864
    ds_read_b64_tr_b16 v[202:203], v10 offset:38912
    s_add_u32 m0, s58, 16384
    s_nop 0
    buffer_load_dwordx4 v15, s[16:19], s33 offen offset:1024 nt lds
    s_waitcnt lgkmcnt(5)
    v_mfma_f32_32x32x16_bf16 v[176:191], v[208:211], v[88:91], v[176:191]
    ds_read_b64_tr_b16 v[204:205], v11 offset:36864
    ds_read_b64_tr_b16 v[206:207], v11 offset:38912
    s_waitcnt lgkmcnt(4)
    v_mfma_f32_32x32x16_bf16 v[176:191], v[212:215], v[92:95], v[176:191]
    ds_read_b64_tr_b16 v[208:209], v12 offset:36864
    ds_read_b64_tr_b16 v[210:211], v12 offset:38912
    s_nop 1
    ds_read_b64_tr_b16 v[212:213], v13 offset:36864
    ds_read_b64_tr_b16 v[214:215], v13 offset:38912
    s_nop 7
    v_max3_f32 v20, v176, v177, v178
    v_max3_f32 v20, v20, v179, v180
    v_max3_f32 v20, v20, v181, v182
    v_max3_f32 v20, v20, v183, v184
    v_max3_f32 v20, v20, v185, v186
    v_max3_f32 v20, v20, v187, v188
    v_max3_f32 v20, v20, v189, v190
    v_max_f32 v20, v20, v191
    v_mov_b32 v21, v20
    s_nop 1
    v_permlane32_swap_b32 v20, v21
    v_max_f32 v20, v20, v21
    v_sub_f32 v160, 0, v20
    v_sub_f32 v161, 0, v20
    v_sub_f32 v162, 0, v20
    v_sub_f32 v163, 0, v20
    v_sub_f32 v164, 0, v20
    v_sub_f32 v165, 0, v20
    v_sub_f32 v166, 0, v20
    v_sub_f32 v167, 0, v20
    v_sub_f32 v168, 0, v20
    v_sub_f32 v169, 0, v20
    v_sub_f32 v170, 0, v20
    v_sub_f32 v171, 0, v20
    v_sub_f32 v172, 0, v20
    v_sub_f32 v173, 0, v20
    v_sub_f32 v174, 0, v20
    v_sub_f32 v175, 0, v20
    v_sub_f32 v176, v176, v20
    v_sub_f32 v177, v177, v20
    v_sub_f32 v178, v178, v20
    v_sub_f32 v179, v179, v20
    v_sub_f32 v180, v180, v20
    v_sub_f32 v181, v181, v20
    v_sub_f32 v182, v182, v20
    v_sub_f32 v183, v183, v20
    v_sub_f32 v184, v184, v20
    v_sub_f32 v185, v185, v20
    v_sub_f32 v186, v186, v20
    v_sub_f32 v187, v187, v20
    v_sub_f32 v188, v188, v20
    v_sub_f32 v189, v189, v20
    v_sub_f32 v190, v190, v20
    v_sub_f32 v191, v191, v20
L_sm8:
    v_exp_f32 v22, v176
    v_exp_f32 v23, v177
    s_nop 0
    v_add_f32 v20, v22, v23
    v_cvt_pk_bf16_f32 v192, v22, v23
    v_exp_f32 v24, v178
    v_exp_f32 v25, v179
    v_add_f32 v20, v20, v24
    v_add_f32 v20, v20, v25
    v_cvt_pk_bf16_f32 v193, v24, v25
    v_exp_f32 v22, v180
    v_exp_f32 v23, v181
    v_add_f32 v20, v20, v22
    v_add_f32 v20, v20, v23
    v_cvt_pk_bf16_f32 v194, v22, v23
    v_exp_f32 v24, v182
    v_exp_f32 v25, v183
    v_add_f32 v20, v20, v24
    v_add_f32 v20, v20, v25
    v_cvt_pk_bf16_f32 v195, v24, v25
    v_exp_f32 v22, v184
    v_exp_f32 v23, v185
    v_add_f32 v20, v20, v22
    v_add_f32 v20, v20, v23
    v_cvt_pk_bf16_f32 v196, v22, v23
    v_exp_f32 v24, v186
    v_exp_f32 v25, v187
    v_add_f32 v20, v20, v24
    v_add_f32 v20, v20, v25
    v_cvt_pk_bf16_f32 v197, v24, v25
    v_exp_f32 v22, v188
    v_exp_f32 v23, v189
    v_add_f32 v20, v20, v22
    v_add_f32 v20, v20, v23
    v_cvt_pk_bf16_f32 v198, v22, v23
    v_exp_f32 v24, v190
    v_exp_f32 v25, v191
    v_add_f32 v20, v20, v24
    v_add_f32 v20, v20, v25
    v_cvt_pk_bf16_f32 v199, v24, v25
    v_mov_b32 v19, v20
    v_mfma_f32_32x32x16_bf16 v[96:111], v[232:235], v[192:195], 0
    v_mfma_f32_32x32x16_bf16 v[112:127], v[236:239], v[192:195], 0
    s_add_u32 m0, s58, 65536
    s_nop 0
    buffer_load_dwordx4 v16, s[24:27], s33 offen offset:0 nt lds
    v_mfma_f32_32x32x16_bf16 v[128:143], v[240:243], v[192:195], 0
    v_mfma_f32_32x32x16_bf16 v[144:159], v[244:247], v[192:195], 0
    s_waitcnt lgkmcnt(6)
    v_mfma_f32_32x32x16_bf16 v[96:111], v[200:203], v[196:199], v[96:111]
    s_waitcnt lgkmcnt(4)
    v_mfma_f32_32x32x16_bf16 v[112:127], v[204:207], v[196:199], v[112:127]
    s_add_u32 m0, s58, 65536
    s_nop 0
    buffer_load_dwordx4 v16, s[24:27], s33 offen offset:1024 nt lds
    s_waitcnt lgkmcnt(2)
    v_mfma_f32_32x32x16_bf16 v[128:143], v[208:211], v[196:199], v[128:143]
    s_waitcnt lgkmcnt(0)
    v_mfma_f32_32x32x16_bf16 v[144:159], v[212:215], v[196:199], v[144:159]
    s_waitcnt lgkmcnt(0)
    s_waitcnt vmcnt(8)
    s_barrier
    s_lshl_b32 s21, s4, 14
    s_add_u32 s22, s21, 0xfffec000
    s_sub_u32 s23, 0xffff0000, s21
    v_add_u32 v28, s22, v28
    v_add_u32 v29, s23, v29

    ds_read_b128 v[200:203], v2 offset:0
    ds_read_b128 v[204:207], v3 offset:0
    ds_read_b128 v[208:211], v4 offset:0
    ds_read_b128 v[212:215], v5 offset:0
    s_waitcnt lgkmcnt(3)
    v_mfma_f32_32x32x16_bf16 v[176:191], v[200:203], v[64:67], v[160:175]
    ds_read_b64_tr_b16 v[232:233], v10 offset:0
    ds_read_b64_tr_b16 v[234:235], v10 offset:2048
    s_waitcnt lgkmcnt(4)
    v_mfma_f32_32x32x16_bf16 v[176:191], v[204:207], v[68:71], v[176:191]
    ds_read_b128 v[200:203], v6 offset:0
    ds_read_b64_tr_b16 v[236:237], v11 offset:0
    ds_read_b64_tr_b16 v[238:239], v11 offset:2048
    s_add_u32 m0, s58, 32768
    s_add_u32 s33, s74, 49152
    s_and_b32 s33, s33, 0x1ffff
    s_add_u32 s33, s33, 524288
    s_add_u32 s33, s33, s36
    buffer_load_dwordx4 v14, s[16:19], s33 offen offset:0 nt lds
    s_waitcnt lgkmcnt(6)
    v_mfma_f32_32x32x16_bf16 v[176:191], v[208:211], v[72:75], v[176:191]
    ds_read_b128 v[204:207], v7 offset:0
    ds_read_b64_tr_b16 v[240:241], v12 offset:0
    ds_read_b64_tr_b16 v[242:243], v12 offset:2048
    s_waitcnt lgkmcnt(8)
    v_mfma_f32_32x32x16_bf16 v[176:191], v[212:215], v[76:79], v[176:191]
    ds_read_b128 v[208:211], v8 offset:0
    ds_read_b64_tr_b16 v[244:245], v13 offset:0
    ds_read_b64_tr_b16 v[246:247], v13 offset:2048
    s_add_u32 m0, s45, 98304
    s_add_u32 s32, s46, 0
    buffer_load_dwordx4 v18, s[12:15], s32 offen lds
    s_waitcnt lgkmcnt(8)
    v_mfma_f32_32x32x16_bf16 v[176:191], v[200:203], v[80:83], v[176:191]
    ds_read_b128 v[212:215], v9 offset:0
    s_waitcnt lgkmcnt(6)
    v_mfma_f32_32x32x16_bf16 v[176:191], v[204:207], v[84:87], v[176:191]
    ds_read_b64_tr_b16 v[200:201], v10 offset:4096
    ds_read_b64_tr_b16 v[202:203], v10 offset:6144
    s_add_u32 m0, s58, 32768
    s_nop 0
    buffer_load_dwordx4 v15, s[16:19], s33 offen offset:1024 nt lds
    s_waitcnt lgkmcnt(5)
    v_mfma_f32_32x32x16_bf16 v[176:191], v[208:211], v[88:91], v[176:191]
    ds_read_b64_tr_b16 v[204:205], v11 offset:4096
    ds_read_b64_tr_b16 v[206:207], v11 offset:6144
    s_waitcnt lgkmcnt(4)
    v_mfma_f32_32x32x16_bf16 v[176:191], v[212:215], v[92:95], v[176:191]
    ds_read_b64_tr_b16 v[208:209], v12 offset:4096
    ds_read_b64_tr_b16 v[210:211], v12 offset:6144
    s_nop 1
    ds_read_b64_tr_b16 v[212:213], v13 offset:4096
    ds_read_b64_tr_b16 v[214:215], v13 offset:6144
    s_nop 7
L_sm9:
    v_exp_f32 v22, v176
    v_exp_f32 v23, v177
    s_nop 0
    v_add_f32 v20, v22, v23
    v_cvt_pk_bf16_f32 v192, v22, v23
    v_exp_f32 v24, v178
    v_exp_f32 v25, v179
    v_add_f32 v20, v20, v24
    v_add_f32 v20, v20, v25
    v_cvt_pk_bf16_f32 v193, v24, v25
    v_exp_f32 v22, v180
    v_exp_f32 v23, v181
    v_add_f32 v20, v20, v22
    v_add_f32 v20, v20, v23
    v_cvt_pk_bf16_f32 v194, v22, v23
    v_exp_f32 v24, v182
    v_exp_f32 v25, v183
    v_add_f32 v20, v20, v24
    v_add_f32 v20, v20, v25
    v_cvt_pk_bf16_f32 v195, v24, v25
    v_exp_f32 v22, v184
    v_exp_f32 v23, v185
    v_add_f32 v20, v20, v22
    v_add_f32 v20, v20, v23
    v_cvt_pk_bf16_f32 v196, v22, v23
    v_exp_f32 v24, v186
    v_exp_f32 v25, v187
    v_add_f32 v20, v20, v24
    v_add_f32 v20, v20, v25
    v_cvt_pk_bf16_f32 v197, v24, v25
    v_exp_f32 v22, v188
    v_exp_f32 v23, v189
    v_add_f32 v20, v20, v22
    v_add_f32 v20, v20, v23
    v_cvt_pk_bf16_f32 v198, v22, v23
    v_exp_f32 v24, v190
    v_exp_f32 v25, v191
    v_add_f32 v20, v20, v24
    v_add_f32 v20, v20, v25
    v_cvt_pk_bf16_f32 v199, v24, v25
    v_cmp_lt_f32 vcc, s43, v20
    s_mov_b32 s41, 9
    s_cbranch_vccnz L_rare
    v_add_f32 v19, v19, v20
    v_mfma_f32_32x32x16_bf16 v[96:111], v[232:235], v[192:195], v[96:111]
    v_mfma_f32_32x32x16_bf16 v[112:127], v[236:239], v[192:195], v[112:127]
    s_add_u32 m0, s58, 81920
    s_nop 0
    buffer_load_dwordx4 v16, s[24:27], s33 offen offset:0 nt lds
    v_mfma_f32_32x32x16_bf16 v[128:143], v[240:243], v[192:195], v[128:143]
    v_mfma_f32_32x32x16_bf16 v[144:159], v[244:247], v[192:195], v[144:159]
    s_add_u32 m0, s45, 106496
    s_add_u32 s32, s46, 65536
    buffer_load_dwordx4 v18, s[12:15], s32 offen lds
    s_waitcnt lgkmcnt(6)
    v_mfma_f32_32x32x16_bf16 v[96:111], v[200:203], v[196:199], v[96:111]
    s_waitcnt lgkmcnt(4)
    v_mfma_f32_32x32x16_bf16 v[112:127], v[204:207], v[196:199], v[112:127]
    s_add_u32 m0, s58, 81920
    s_nop 0
    buffer_load_dwordx4 v16, s[24:27], s33 offen offset:1024 nt lds
    s_waitcnt lgkmcnt(2)
    v_mfma_f32_32x32x16_bf16 v[128:143], v[208:211], v[196:199], v[128:143]
    s_waitcnt lgkmcnt(0)
    v_mfma_f32_32x32x16_bf16 v[144:159], v[212:215], v[196:199], v[144:159]
    s_waitcnt lgkmcnt(0)
    s_waitcnt vmcnt(6)
    s_barrier
    s_cmp_eq_u32 s3, 7
    s_cbranch_scc0 nf_13
    v_mov_b32 v254, 0
    v_mov_b32 v255, 1
    s_mov_b64 exec, 1
    buffer_store_dword v255, v254, s[88:91], s75 offen offset:0 sc1
    s_mov_b64 exec, -1
nf_13:

    ds_read_b128 v[200:203], v2 offset:16384
    ds_read_b128 v[204:207], v3 offset:16384
    ds_read_b128 v[208:211], v4 offset:16384
    ds_read_b128 v[212:215], v5 offset:16384
    s_waitcnt lgkmcnt(3)
    v_mfma_f32_32x32x16_bf16 v[176:191], v[200:203], v[64:67], v[160:175]
    ds_read_b64_tr_b16 v[232:233], v10 offset:16384
    ds_read_b64_tr_b16 v[234:235], v10 offset:18432
    s_waitcnt lgkmcnt(4)
    v_mfma_f32_32x32x16_bf16 v[176:191], v[204:207], v[68:71], v[176:191]
    ds_read_b128 v[200:203], v6 offset:16384
    ds_read_b64_tr_b16 v[236:237], v11 offset:16384
    ds_read_b64_tr_b16 v[238:239], v11 offset:18432
    s_add_u32 m0, s58, 0
    s_add_u32 s33, s74, 65536
    s_and_b32 s33, s33, 0x1ffff
    s_add_u32 s33, s33, 524288
    s_add_u32 s33, s33, s36
    buffer_load_dwordx4 v14, s[16:19], s33 offen offset:0 nt lds
    s_waitcnt lgkmcnt(6)
    v_mfma_f32_32x32x16_bf16 v[176:191], v[208:211], v[72:75], v[176:191]
    ds_read_b128 v[204:207], v7 offset:16384
    ds_read_b64_tr_b16 v[240:241], v12 offset:16384
    ds_read_b64_tr_b16 v[242:243], v12 offset:18432
    s_waitcnt lgkmcnt(8)
    v_mfma_f32_32x32x16_bf16 v[176:191], v[212:215], v[76:79], v[176:191]
    ds_read_b128 v[208:211], v8 offset:16384
    ds_read_b64_tr_b16 v[244:245], v13 offset:16384
    ds_read_b64_tr_b16 v[246:247], v13 offset:18432
    s_add_u32 m0, s45, 114688
    s_add_u32 s32, s46, 32768
    buffer_load_dwordx4 v18, s[12:15], s32 offen lds
    s_waitcnt lgkmcnt(8)
    v_mfma_f32_32x32x16_bf16 v[176:191], v[200:203], v[80:83], v[176:191]
    ds_read_b128 v[212:215], v9 offset:16384
    s_waitcnt lgkmcnt(6)
    v_mfma_f32_32x32x16_bf16 v[176:191], v[204:207], v[84:87], v[176:191]
    ds_read_b64_tr_b16 v[200:201], v10 offset:20480
    ds_read_b64_tr_b16 v[202:203], v10 offset:22528
    s_add_u32 m0, s58, 0
    s_nop 0
    buffer_load_dwordx4 v15, s[16:19], s33 offen offset:1024 nt lds
    s_waitcnt lgkmcnt(5)
    v_mfma_f32_32x32x16_bf16 v[176:191], v[208:211], v[88:91], v[176:191]
    ds_read_b64_tr_b16 v[204:205], v11 offset:20480
    ds_read_b64_tr_b16 v[206:207], v11 offset:22528
    s_waitcnt lgkmcnt(4)
    v_mfma_f32_32x32x16_bf16 v[176:191], v[212:215], v[92:95], v[176:191]
    ds_read_b64_tr_b16 v[208:209], v12 offset:20480
    ds_read_b64_tr_b16 v[210:211], v12 offset:22528
    s_nop 1
    ds_read_b64_tr_b16 v[212:213], v13 offset:20480
    ds_read_b64_tr_b16 v[214:215], v13 offset:22528
    s_nop 7
L_sm10:
    v_exp_f32 v22, v176
    v_exp_f32 v23, v177
    s_nop 0
    v_add_f32 v20, v22, v23
    v_cvt_pk_bf16_f32 v192, v22, v23
    v_exp_f32 v24, v178
    v_exp_f32 v25, v179
    v_add_f32 v20, v20, v24
    v_add_f32 v20, v20, v25
    v_cvt_pk_bf16_f32 v193, v24, v25
    v_exp_f32 v22, v180
    v_exp_f32 v23, v181
    v_add_f32 v20, v20, v22
    v_add_f32 v20, v20, v23
    v_cvt_pk_bf16_f32 v194, v22, v23
    v_exp_f32 v24, v182
    v_exp_f32 v25, v183
    v_add_f32 v20, v20, v24
    v_add_f32 v20, v20, v25
    v_cvt_pk_bf16_f32 v195, v24, v25
    v_exp_f32 v22, v184
    v_exp_f32 v23, v185
    v_add_f32 v20, v20, v22
    v_add_f32 v20, v20, v23
    v_cvt_pk_bf16_f32 v196, v22, v23
    v_exp_f32 v24, v186
    v_exp_f32 v25, v187
    v_add_f32 v20, v20, v24
    v_add_f32 v20, v20, v25
    v_cvt_pk_bf16_f32 v197, v24, v25
    v_exp_f32 v22, v188
    v_exp_f32 v23, v189
    v_add_f32 v20, v20, v22
    v_add_f32 v20, v20, v23
    v_cvt_pk_bf16_f32 v198, v22, v23
    v_exp_f32 v24, v190
    v_exp_f32 v25, v191
    v_add_f32 v20, v20, v24
    v_add_f32 v20, v20, v25
    v_cvt_pk_bf16_f32 v199, v24, v25
    v_cmp_lt_f32 vcc, s43, v20
    s_mov_b32 s41, 10
    s_cbranch_vccnz L_rare
    v_add_f32 v19, v19, v20
    v_mfma_f32_32x32x16_bf16 v[96:111], v[232:235], v[192:195], v[96:111]
    v_mfma_f32_32x32x16_bf16 v[112:127], v[236:239], v[192:195], v[112:127]
    s_add_u32 m0, s58, 49152
    s_nop 0
    buffer_load_dwordx4 v16, s[24:27], s33 offen offset:0 nt lds
    v_mfma_f32_32x32x16_bf16 v[128:143], v[240:243], v[192:195], v[128:143]
    v_mfma_f32_32x32x16_bf16 v[144:159], v[244:247], v[192:195], v[144:159]
    s_add_u32 m0, s45, 122880
    s_add_u32 s32, s46, 98304
    buffer_load_dwordx4 v18, s[12:15], s32 offen lds
    s_waitcnt lgkmcnt(6)
    v_mfma_f32_32x32x16_bf16 v[96:111], v[200:203], v[196:199], v[96:111]
    s_waitcnt lgkmcnt(4)
    v_mfma_f32_32x32x16_bf16 v[112:127], v[204:207], v[196:199], v[112:127]
    s_add_u32 m0, s58, 49152
    s_nop 0
    buffer_load_dwordx4 v16, s[24:27], s33 offen offset:1024 nt lds
    s_waitcnt lgkmcnt(2)
    v_mfma_f32_32x32x16_bf16 v[128:143], v[208:211], v[196:199], v[128:143]
    s_waitcnt lgkmcnt(0)
    v_mfma_f32_32x32x16_bf16 v[144:159], v[212:215], v[196:199], v[144:159]
    s_waitcnt lgkmcnt(0)
    s_waitcnt vmcnt(6)
    s_barrier
    ds_read_b128 v[200:203], v2 offset:32768
    ds_read_b128 v[204:207], v3 offset:32768
    ds_read_b128 v[208:211], v4 offset:32768
    ds_read_b128 v[212:215], v5 offset:32768
    s_waitcnt lgkmcnt(3)
    v_mfma_f32_32x32x16_bf16 v[176:191], v[200:203], v[64:67], v[160:175]
    ds_read_b64_tr_b16 v[232:233], v10 offset:32768
    ds_read_b64_tr_b16 v[234:235], v10 offset:34816
    s_waitcnt lgkmcnt(4)
    v_mfma_f32_32x32x16_bf16 v[176:191], v[204:207], v[68:71], v[176:191]
    ds_read_b128 v[200:203], v6 offset:32768
    ds_read_b64_tr_b16 v[236:237], v11 offset:32768
    ds_read_b64_tr_b16 v[238:239], v11 offset:34816
    s_add_u32 m0, s58, 16384
    s_add_u32 s33, s74, 81920
    s_and_b32 s33, s33, 0x1ffff
    s_add_u32 s33, s33, 524288
    s_add_u32 s33, s33, s36
    buffer_load_dwordx4 v14, s[16:19], s33 offen offset:0 nt lds
    s_waitcnt lgkmcnt(6)
    v_mfma_f32_32x32x16_bf16 v[176:191], v[208:211], v[72:75], v[176:191]
    ds_read_b128 v[204:207], v7 offset:32768
    ds_read_b64_tr_b16 v[240:241], v12 offset:32768
    ds_read_b64_tr_b16 v[242:243], v12 offset:34816
    s_waitcnt lgkmcnt(8)
    v_mfma_f32_32x32x16_bf16 v[176:191], v[212:215], v[76:79], v[176:191]
    ds_read_b128 v[208:211], v8 offset:32768
    ds_read_b64_tr_b16 v[244:245], v13 offset:32768
    ds_read_b64_tr_b16 v[246:247], v13 offset:34816
    s_add_u32 m0, s45, 131072
    s_add_u32 s32, s47, 0
    buffer_load_dwordx4 v18, s[12:15], s32 offen lds
    s_waitcnt lgkmcnt(8)
    v_mfma_f32_32x32x16_bf16 v[176:191], v[200:203], v[80:83], v[176:191]
    ds_read_b128 v[212:215], v9 offset:32768
    s_waitcnt lgkmcnt(6)
    v_mfma_f32_32x32x16_bf16 v[176:191], v[204:207], v[84:87], v[176:191]
    ds_read_b64_tr_b16 v[200:201], v10 offset:36864
    ds_read_b64_tr_b16 v[202:203], v10 offset:38912
    s_add_u32 m0, s58, 16384
    s_nop 0
    buffer_load_dwordx4 v15, s[16:19], s33 offen offset:1024 nt lds
    s_waitcnt lgkmcnt(5)
    v_mfma_f32_32x32x16_bf16 v[176:191], v[208:211], v[88:91], v[176:191]
    ds_read_b64_tr_b16 v[204:205], v11 offset:36864
    ds_read_b64_tr_b16 v[206:207], v11 offset:38912
    s_waitcnt lgkmcnt(4)
    v_mfma_f32_32x32x16_bf16 v[176:191], v[212:215], v[92:95], v[176:191]
    ds_read_b64_tr_b16 v[208:209], v12 offset:36864
    ds_read_b64_tr_b16 v[210:211], v12 offset:38912
    s_cmp_eq_u32 s3, 0
    s_cbranch_scc0 si_14
    s_lshl_b32 s34, s6, 3
    s_add_u32 s34, s34, s7
    s_lshl_b32 s34, s34, 4
    buffer_load_dword v251, off, s[96:99], s34 sc1
si_14:
    s_nop 1
    ds_read_b64_tr_b16 v[212:213], v13 offset:36864
    ds_read_b64_tr_b16 v[214:215], v13 offset:38912
    s_nop 7
L_sm11:
    v_exp_f32 v22, v176
    v_exp_f32 v23, v177
    s_nop 0
    v_add_f32 v20, v22, v23
    v_cvt_pk_bf16_f32 v192, v22, v23
    v_exp_f32 v24, v178
    v_exp_f32 v25, v179
    v_add_f32 v20, v20, v24
    v_add_f32 v20, v20, v25
    v_cvt_pk_bf16_f32 v193, v24, v25
    v_exp_f32 v22, v180
    v_exp_f32 v23, v181
    v_add_f32 v20, v20, v22
    v_add_f32 v20, v20, v23
    v_cvt_pk_bf16_f32 v194, v22, v23
    v_exp_f32 v24, v182
    v_exp_f32 v25, v183
    v_add_f32 v20, v20, v24
    v_add_f32 v20, v20, v25
    v_cvt_pk_bf16_f32 v195, v24, v25
    v_exp_f32 v22, v184
    v_exp_f32 v23, v185
    v_add_f32 v20, v20, v22
    v_add_f32 v20, v20, v23
    v_cvt_pk_bf16_f32 v196, v22, v23
    v_exp_f32 v24, v186
    v_exp_f32 v25, v187
    v_add_f32 v20, v20, v24
    v_add_f32 v20, v20, v25
    v_cvt_pk_bf16_f32 v197, v24, v25
    v_exp_f32 v22, v188
    v_exp_f32 v23, v189
    v_add_f32 v20, v20, v22
    v_add_f32 v20, v20, v23
    v_cvt_pk_bf16_f32 v198, v22, v23
    v_exp_f32 v24, v190
    v_exp_f32 v25, v191
    v_add_f32 v20, v20, v24
    v_add_f32 v20, v20, v25
    v_cvt_pk_bf16_f32 v199, v24, v25
    v_cmp_lt_f32 vcc, s43, v20
    s_mov_b32 s41, 11
    s_cbranch_vccnz L_rare
    v_add_f32 v19, v19, v20
    v_mfma_f32_32x32x16_bf16 v[96:111], v[232:235], v[192:195], v[96:111]
    v_mfma_f32_32x32x16_bf16 v[112:127], v[236:239], v[192:195], v[112:127]
    s_add_u32 m0, s58, 65536
    s_nop 0
    buffer_load_dwordx4 v16, s[24:27], s33 offen offset:0 nt lds
    v_mfma_f32_32x32x16_bf16 v[128:143], v[240:243], v[192:195], v[128:143]
    v_mfma_f32_32x32x16_bf16 v[144:159], v[244:247], v[192:195], v[144:159]
    s_add_u32 m0, s45, 139264
    s_add_u32 s32, s47, 65536
    buffer_load_dwordx4 v18, s[12:15], s32 offen lds
    s_waitcnt lgkmcnt(6)
    v_mfma_f32_32x32x16_bf16 v[96:111], v[200:203], v[196:199], v[96:111]
    s_waitcnt lgkmcnt(4)
    v_mfma_f32_32x32x16_bf16 v[112:127], v[204:207], v[196:199], v[112:127]
    s_add_u32 m0, s58, 65536
    s_nop 0
    buffer_load_dwordx4 v16, s[24:27], s33 offen offset:1024 nt lds
    s_waitcnt lgkmcnt(2)
    v_mfma_f32_32x32x16_bf16 v[128:143], v[208:211], v[196:199], v[128:143]
    s_waitcnt lgkmcnt(0)
    v_mfma_f32_32x32x16_bf16 v[144:159], v[212:215], v[196:199], v[144:159]
    s_waitcnt lgkmcnt(0)
    s_waitcnt vmcnt(6)
    s_barrier
    ds_read_b128 v[200:203], v2 offset:0
    ds_read_b128 v[204:207], v3 offset:0
    ds_read_b128 v[208:211], v4 offset:0
    ds_read_b128 v[212:215], v5 offset:0
    s_waitcnt lgkmcnt(3)
    v_mfma_f32_32x32x16_bf16 v[176:191], v[200:203], v[64:67], v[160:175]
    ds_read_b64_tr_b16 v[232:233], v10 offset:0
    ds_read_b64_tr_b16 v[234:235], v10 offset:2048
    s_waitcnt lgkmcnt(4)
    v_mfma_f32_32x32x16_bf16 v[176:191], v[204:207], v[68:71], v[176:191]
    ds_read_b128 v[200:203], v6 offset:0
    ds_read_b64_tr_b16 v[236:237], v11 offset:0
    ds_read_b64_tr_b16 v[238:239], v11 offset:2048
    s_add_u32 m0, s58, 32768
    s_add_u32 s33, s74, 98304
    s_and_b32 s33, s33, 0x1ffff
    s_add_u32 s33, s33, 524288
    s_add_u32 s33, s33, s36
    buffer_load_dwordx4 v14, s[16:19], s33 offen offset:0 nt lds
    s_waitcnt lgkmcnt(6)
    v_mfma_f32_32x32x16_bf16 v[176:191], v[208:211], v[72:75], v[176:191]
    ds_read_b128 v[204:207], v7 offset:0
    ds_read_b64_tr_b16 v[240:241], v12 offset:0
    ds_read_b64_tr_b16 v[242:243], v12 offset:2048
    s_waitcnt lgkmcnt(8)
    v_mfma_f32_32x32x16_bf16 v[176:191], v[212:215], v[76:79], v[176:191]
    ds_read_b128 v[208:211], v8 offset:0
    ds_read_b64_tr_b16 v[244:245], v13 offset:0
    ds_read_b64_tr_b16 v[246:247], v13 offset:2048
    s_add_u32 m0, s45, 147456
    s_add_u32 s32, s47, 32768
    buffer_load_dwordx4 v18, s[12:15], s32 offen lds
    s_waitcnt lgkmcnt(8)
    v_mfma_f32_32x32x16_bf16 v[176:191], v[200:203], v[80:83], v[176:191]
    ds_read_b128 v[212:215], v9 offset:0
    s_waitcnt lgkmcnt(6)
    v_mfma_f32_32x32x16_bf16 v[176:191], v[204:207], v[84:87], v[176:191]
    ds_read_b64_tr_b16 v[200:201], v10 offset:4096
    ds_read_b64_tr_b16 v[202:203], v10 offset:6144
    s_add_u32 m0, s58, 32768
    s_nop 0
    buffer_load_dwordx4 v15, s[16:19], s33 offen offset:1024 nt lds
    s_waitcnt lgkmcnt(5)
    v_mfma_f32_32x32x16_bf16 v[176:191], v[208:211], v[88:91], v[176:191]
    ds_read_b64_tr_b16 v[204:205], v11 offset:4096
    ds_read_b64_tr_b16 v[206:207], v11 offset:6144
    s_waitcnt lgkmcnt(4)
    v_mfma_f32_32x32x16_bf16 v[176:191], v[212:215], v[92:95], v[176:191]
    ds_read_b64_tr_b16 v[208:209], v12 offset:4096
    ds_read_b64_tr_b16 v[210:211], v12 offset:6144
    s_nop 1
    ds_read_b64_tr_b16 v[212:213], v13 offset:4096
    ds_read_b64_tr_b16 v[214:215], v13 offset:6144
    s_nop 7
L_sm12:
    v_exp_f32 v22, v176
    v_exp_f32 v23, v177
    s_nop 0
    v_add_f32 v20, v22, v23
    v_cvt_pk_bf16_f32 v192, v22, v23
    v_exp_f32 v24, v178
    v_exp_f32 v25, v179
    v_add_f32 v20, v20, v24
    v_add_f32 v20, v20, v25
    v_cvt_pk_bf16_f32 v193, v24, v25
    v_exp_f32 v22, v180
    v_exp_f32 v23, v181
    v_add_f32 v20, v20, v22
    v_add_f32 v20, v20, v23
    v_cvt_pk_bf16_f32 v194, v22, v23
    v_exp_f32 v24, v182
    v_exp_f32 v25, v183
    v_add_f32 v20, v20, v24
    v_add_f32 v20, v20, v25
    v_cvt_pk_bf16_f32 v195, v24, v25
    v_exp_f32 v22, v184
    v_exp_f32 v23, v185
    v_add_f32 v20, v20, v22
    v_add_f32 v20, v20, v23
    v_cvt_pk_bf16_f32 v196, v22, v23
    v_exp_f32 v24, v186
    v_exp_f32 v25, v187
    v_add_f32 v20, v20, v24
    v_add_f32 v20, v20, v25
    v_cvt_pk_bf16_f32 v197, v24, v25
    v_exp_f32 v22, v188
    v_exp_f32 v23, v189
    v_add_f32 v20, v20, v22
    v_add_f32 v20, v20, v23
    v_cvt_pk_bf16_f32 v198, v22, v23
    v_exp_f32 v24, v190
    v_exp_f32 v25, v191
    v_add_f32 v20, v20, v24
    v_add_f32 v20, v20, v25
    v_cvt_pk_bf16_f32 v199, v24, v25
    v_cmp_lt_f32 vcc, s43, v20
    s_mov_b32 s41, 12
    s_cbranch_vccnz L_rare
    v_add_f32 v19, v19, v20
    v_mfma_f32_32x32x16_bf16 v[96:111], v[232:235], v[192:195], v[96:111]
    v_mfma_f32_32x32x16_bf16 v[112:127], v[236:239], v[192:195], v[112:127]
    s_add_u32 m0, s58, 81920
    s_nop 0
    buffer_load_dwordx4 v16, s[24:27], s33 offen offset:0 nt lds
    v_mfma_f32_32x32x16_bf16 v[128:143], v[240:243], v[192:195], v[128:143]
    v_mfma_f32_32x32x16_bf16 v[144:159], v[244:247], v[192:195], v[144:159]
    s_add_u32 m0, s45, 155648
    s_add_u32 s32, s47, 98304
    buffer_load_dwordx4 v18, s[12:15], s32 offen lds
    s_waitcnt lgkmcnt(6)
    v_mfma_f32_32x32x16_bf16 v[96:111], v[200:203], v[196:199], v[96:111]
    s_waitcnt lgkmcnt(4)
    v_mfma_f32_32x32x16_bf16 v[112:127], v[204:207], v[196:199], v[112:127]
    s_add_u32 m0, s58, 81920
    s_nop 0
    buffer_load_dwordx4 v16, s[24:27], s33 offen offset:1024 nt lds
    s_waitcnt lgkmcnt(2)
    v_mfma_f32_32x32x16_bf16 v[128:143], v[208:211], v[196:199], v[128:143]
    s_waitcnt lgkmcnt(0)
    v_mfma_f32_32x32x16_bf16 v[144:159], v[212:215], v[196:199], v[144:159]
    s_waitcnt lgkmcnt(0)
    s_waitcnt vmcnt(6)
    s_barrier
    s_cmp_eq_u32 s3, 0
    s_cbranch_scc0 sc_15
    s_waitcnt vmcnt(9)
    s_mov_b32 s35, 0
plp_17:
    v_readfirstlane_b32 s34, v251
    s_cmp_eq_u32 s34, 16
    s_cbranch_scc1 pok_16
    s_add_u32 s35, s35, 1
    s_cmp_ge_u32 s35, 50000
    s_cbranch_scc1 pok_16
    s_lshl_b32 s34, s6, 3
    s_add_u32 s34, s34, s7
    s_lshl_b32 s34, s34, 4
    buffer_load_dword v251, off, s[96:99], s34 sc1
    s_waitcnt vmcnt(0)
    s_branch plp_17
pok_16:
sc_15:
    ds_read_b128 v[200:203], v2 offset:16384
    ds_read_b128 v[204:207], v3 offset:16384
    ds_read_b128 v[208:211], v4 offset:16384
    ds_read_b128 v[212:215], v5 offset:16384
    s_waitcnt lgkmcnt(3)
    v_mfma_f32_32x32x16_bf16 v[176:191], v[200:203], v[64:67], v[160:175]
    ds_read_b64_tr_b16 v[232:233], v10 offset:16384
    ds_read_b64_tr_b16 v[234:235], v10 offset:18432
    s_waitcnt lgkmcnt(4)
    v_mfma_f32_32x32x16_bf16 v[176:191], v[204:207], v[68:71], v[176:191]
    ds_read_b128 v[200:203], v6 offset:16384
    ds_read_b64_tr_b16 v[236:237], v11 offset:16384
    ds_read_b64_tr_b16 v[238:239], v11 offset:18432
    s_add_u32 m0, s58, 0
    s_add_u32 s33, s74, 114688
    s_and_b32 s33, s33, 0x1ffff
    s_add_u32 s33, s33, 524288
    s_add_u32 s33, s33, s36
    buffer_load_dwordx4 v14, s[16:19], s33 offen offset:0 nt lds
    s_waitcnt lgkmcnt(6)
    v_mfma_f32_32x32x16_bf16 v[176:191], v[208:211], v[72:75], v[176:191]
    ds_read_b128 v[204:207], v7 offset:16384
    ds_read_b64_tr_b16 v[240:241], v12 offset:16384
    ds_read_b64_tr_b16 v[242:243], v12 offset:18432
    s_waitcnt lgkmcnt(8)
    v_mfma_f32_32x32x16_bf16 v[176:191], v[212:215], v[76:79], v[176:191]
    ds_read_b128 v[208:211], v8 offset:16384
    ds_read_b64_tr_b16 v[244:245], v13 offset:16384
    ds_read_b64_tr_b16 v[246:247], v13 offset:18432
    s_cmp_eq_u32 s3, 0
    s_cbranch_scc0 si_18
    buffer_load_dword v251, v248, s[88:91], s54 offen sc1
si_18:
    s_waitcnt lgkmcnt(8)
    v_mfma_f32_32x32x16_bf16 v[176:191], v[200:203], v[80:83], v[176:191]
    ds_read_b128 v[212:215], v9 offset:16384
    s_waitcnt lgkmcnt(6)
    v_mfma_f32_32x32x16_bf16 v[176:191], v[204:207], v[84:87], v[176:191]
    ds_read_b64_tr_b16 v[200:201], v10 offset:20480
    ds_read_b64_tr_b16 v[202:203], v10 offset:22528
    s_add_u32 m0, s58, 0
    s_nop 0
    buffer_load_dwordx4 v15, s[16:19], s33 offen offset:1024 nt lds
    s_waitcnt lgkmcnt(5)
    v_mfma_f32_32x32x16_bf16 v[176:191], v[208:211], v[88:91], v[176:191]
    ds_read_b64_tr_b16 v[204:205], v11 offset:20480
    ds_read_b64_tr_b16 v[206:207], v11 offset:22528
    s_waitcnt lgkmcnt(4)
    v_mfma_f32_32x32x16_bf16 v[176:191], v[212:215], v[92:95], v[176:191]
    ds_read_b64_tr_b16 v[208:209], v12 offset:20480
    ds_read_b64_tr_b16 v[210:211], v12 offset:22528
    s_nop 1
    ds_read_b64_tr_b16 v[212:213], v13 offset:20480
    ds_read_b64_tr_b16 v[214:215], v13 offset:22528
    s_nop 7
L_sm13:
    v_exp_f32 v22, v176
    v_exp_f32 v23, v177
    s_nop 0
    v_add_f32 v20, v22, v23
    v_cvt_pk_bf16_f32 v192, v22, v23
    v_exp_f32 v24, v178
    v_exp_f32 v25, v179
    v_add_f32 v20, v20, v24
    v_add_f32 v20, v20, v25
    v_cvt_pk_bf16_f32 v193, v24, v25
    v_exp_f32 v22, v180
    v_exp_f32 v23, v181
    v_add_f32 v20, v20, v22
    v_add_f32 v20, v20, v23
    v_cvt_pk_bf16_f32 v194, v22, v23
    v_exp_f32 v24, v182
    v_exp_f32 v25, v183
    v_add_f32 v20, v20, v24
    v_add_f32 v20, v20, v25
    v_cvt_pk_bf16_f32 v195, v24, v25
    v_exp_f32 v22, v184
    v_exp_f32 v23, v185
    v_add_f32 v20, v20, v22
    v_add_f32 v20, v20, v23
    v_cvt_pk_bf16_f32 v196, v22, v23
    v_exp_f32 v24, v186
    v_exp_f32 v25, v187
    v_add_f32 v20, v20, v24
    v_add_f32 v20, v20, v25
    v_cvt_pk_bf16_f32 v197, v24, v25
    v_exp_f32 v22, v188
    v_exp_f32 v23, v189
    v_add_f32 v20, v20, v22
    v_add_f32 v20, v20, v23
    v_cvt_pk_bf16_f32 v198, v22, v23
    v_exp_f32 v24, v190
    v_exp_f32 v25, v191
    v_add_f32 v20, v20, v24
    v_add_f32 v20, v20, v25
    v_cvt_pk_bf16_f32 v199, v24, v25
    v_cmp_lt_f32 vcc, s43, v20
    s_mov_b32 s41, 13
    s_cbranch_vccnz L_rare
    v_add_f32 v19, v19, v20
    v_mfma_f32_32x32x16_bf16 v[96:111], v[232:235], v[192:195], v[96:111]
    v_mfma_f32_32x32x16_bf16 v[112:127], v[236:239], v[192:195], v[112:127]
    s_add_u32 m0, s58, 49152
    s_nop 0
    buffer_load_dwordx4 v16, s[24:27], s33 offen offset:0 nt lds
    v_mfma_f32_32x32x16_bf16 v[128:143], v[240:243], v[192:195], v[128:143]
    v_mfma_f32_32x32x16_bf16 v[144:159], v[244:247], v[192:195], v[144:159]
    s_waitcnt lgkmcnt(6)
    v_mfma_f32_32x32x16_bf16 v[96:111], v[200:203], v[196:199], v[96:111]
    s_waitcnt lgkmcnt(4)
    v_mfma_f32_32x32x16_bf16 v[112:127], v[204:207], v[196:199], v[112:127]
    s_add_u32 m0, s58, 49152
    s_nop 0
    buffer_load_dwordx4 v16, s[24:27], s33 offen offset:1024 nt lds
    s_waitcnt lgkmcnt(2)
    v_mfma_f32_32x32x16_bf16 v[128:143], v[208:211], v[196:199], v[128:143]
    s_waitcnt lgkmcnt(0)
    v_mfma_f32_32x32x16_bf16 v[144:159], v[212:215], v[196:199], v[144:159]
    s_waitcnt lgkmcnt(0)
    s_waitcnt vmcnt(4)
    s_barrier
    ds_read_b128 v[200:203], v2 offset:32768
    ds_read_b128 v[204:207], v3 offset:32768
    ds_read_b128 v[208:211], v4 offset:32768
    ds_read_b128 v[212:215], v5 offset:32768
    s_waitcnt lgkmcnt(3)
    v_mfma_f32_32x32x16_bf16 v[176:191], v[200:203], v[64:67], v[160:175]
    ds_read_b64_tr_b16 v[232:233], v10 offset:32768
    ds_read_b64_tr_b16 v[234:235], v10 offset:34816
    s_waitcnt lgkmcnt(4)
    v_mfma_f32_32x32x16_bf16 v[176:191], v[204:207], v[68:71], v[176:191]
    ds_read_b128 v[200:203], v6 offset:32768
    ds_read_b64_tr_b16 v[236:237], v11 offset:32768
    ds_read_b64_tr_b16 v[238:239], v11 offset:34816
    s_waitcnt lgkmcnt(6)
    v_mfma_f32_32x32x16_bf16 v[176:191], v[208:211], v[72:75], v[176:191]
    ds_read_b128 v[204:207], v7 offset:32768
    ds_read_b64_tr_b16 v[240:241], v12 offset:32768
    ds_read_b64_tr_b16 v[242:243], v12 offset:34816
    s_waitcnt lgkmcnt(8)
    v_mfma_f32_32x32x16_bf16 v[176:191], v[212:215], v[76:79], v[176:191]
    ds_read_b128 v[208:211], v8 offset:32768
    ds_read_b64_tr_b16 v[244:245], v13 offset:32768
    ds_read_b64_tr_b16 v[246:247], v13 offset:34816
    s_waitcnt lgkmcnt(8)
    v_mfma_f32_32x32x16_bf16 v[176:191], v[200:203], v[80:83], v[176:191]
    ds_read_b128 v[212:215], v9 offset:32768
    s_waitcnt lgkmcnt(6)
    v_mfma_f32_32x32x16_bf16 v[176:191], v[204:207], v[84:87], v[176:191]
    ds_read_b64_tr_b16 v[200:201], v10 offset:36864
    ds_read_b64_tr_b16 v[202:203], v10 offset:38912
    s_waitcnt lgkmcnt(5)
    v_mfma_f32_32x32x16_bf16 v[176:191], v[208:211], v[88:91], v[176:191]
    ds_read_b64_tr_b16 v[204:205], v11 offset:36864
    ds_read_b64_tr_b16 v[206:207], v11 offset:38912
    s_waitcnt lgkmcnt(4)
    v_mfma_f32_32x32x16_bf16 v[176:191], v[212:215], v[92:95], v[176:191]
    ds_read_b64_tr_b16 v[208:209], v12 offset:36864
    ds_read_b64_tr_b16 v[210:211], v12 offset:38912
    s_nop 1
    ds_read_b64_tr_b16 v[212:213], v13 offset:36864
    ds_read_b64_tr_b16 v[214:215], v13 offset:38912
    s_nop 7
L_sm14:
    v_exp_f32 v22, v176
    v_exp_f32 v23, v177
    s_nop 0
    v_add_f32 v20, v22, v23
    v_cvt_pk_bf16_f32 v192, v22, v23
    v_exp_f32 v24, v178
    v_exp_f32 v25, v179
    v_add_f32 v20, v20, v24
    v_add_f32 v20, v20, v25
    v_cvt_pk_bf16_f32 v193, v24, v25
    v_exp_f32 v22, v180
    v_exp_f32 v23, v181
    v_add_f32 v20, v20, v22
    v_add_f32 v20, v20, v23
    v_cvt_pk_bf16_f32 v194, v22, v23
    v_exp_f32 v24, v182
    v_exp_f32 v25, v183
    v_add_f32 v20, v20, v24
    v_add_f32 v20, v20, v25
    v_cvt_pk_bf16_f32 v195, v24, v25
    v_exp_f32 v22, v184
    v_exp_f32 v23, v185
    v_add_f32 v20, v20, v22
    v_add_f32 v20, v20, v23
    v_cvt_pk_bf16_f32 v196, v22, v23
    v_exp_f32 v24, v186
    v_exp_f32 v25, v187
    v_add_f32 v20, v20, v24
    v_add_f32 v20, v20, v25
    v_cvt_pk_bf16_f32 v197, v24, v25
    v_exp_f32 v22, v188
    v_exp_f32 v23, v189
    v_add_f32 v20, v20, v22
    v_add_f32 v20, v20, v23
    v_cvt_pk_bf16_f32 v198, v22, v23
    v_exp_f32 v24, v190
    v_exp_f32 v25, v191
    v_add_f32 v20, v20, v24
    v_add_f32 v20, v20, v25
    v_cvt_pk_bf16_f32 v199, v24, v25
    v_cmp_lt_f32 vcc, s43, v20
    s_mov_b32 s41, 14
    s_cbranch_vccnz L_rare
    v_add_f32 v19, v19, v20
    v_mfma_f32_32x32x16_bf16 v[96:111], v[232:235], v[192:195], v[96:111]
    v_mfma_f32_32x32x16_bf16 v[112:127], v[236:239], v[192:195], v[112:127]
    v_mfma_f32_32x32x16_bf16 v[128:143], v[240:243], v[192:195], v[128:143]
    v_mfma_f32_32x32x16_bf16 v[144:159], v[244:247], v[192:195], v[144:159]
    s_waitcnt lgkmcnt(6)
    v_mfma_f32_32x32x16_bf16 v[96:111], v[200:203], v[196:199], v[96:111]
    s_waitcnt lgkmcnt(4)
    v_mfma_f32_32x32x16_bf16 v[112:127], v[204:207], v[196:199], v[112:127]
    s_waitcnt lgkmcnt(2)
    v_mfma_f32_32x32x16_bf16 v[128:143], v[208:211], v[196:199], v[128:143]
    s_waitcnt lgkmcnt(0)
    v_mfma_f32_32x32x16_bf16 v[144:159], v[212:215], v[196:199], v[144:159]
    s_waitcnt lgkmcnt(0)
    s_waitcnt vmcnt(0)
    s_cmp_eq_u32 s3, 0
    s_cbranch_scc0 sc_19
    s_waitcnt vmcnt(3)
    s_mov_b32 s35, 0
plp_21:
    v_cmp_ne_u32 vcc, 1, v251
    s_lshl_b32 s34, 1, s82
    s_andn2_b32 s34, vcc_lo, s34
    s_and_b32 s34, s34, 15
    s_cbranch_scc0 pok_20
    s_add_u32 s35, s35, 1
    s_cmp_ge_u32 s35, 50000
    s_cbranch_scc1 pok_20
    buffer_load_dword v251, v248, s[88:91], s54 offen sc1
    s_waitcnt vmcnt(0)
    s_branch plp_21
pok_20:
sc_19:
    s_barrier
    ds_read_b128 v[200:203], v2 offset:0
    ds_read_b128 v[204:207], v3 offset:0
    ds_read_b128 v[208:211], v4 offset:0
    ds_read_b128 v[212:215], v5 offset:0
    s_waitcnt lgkmcnt(3)
    v_mfma_f32_32x32x16_bf16 v[176:191], v[200:203], v[64:67], v[160:175]
    ds_read_b64_tr_b16 v[232:233], v10 offset:0
    ds_read_b64_tr_b16 v[234:235], v10 offset:2048
    buffer_load_dwordx4 v[32:35], v30, s[28:31], s50 offen offset:0 sc1
    s_waitcnt lgkmcnt(4)
    v_mfma_f32_32x32x16_bf16 v[176:191], v[204:207], v[68:71], v[176:191]
    ds_read_b128 v[200:203], v6 offset:0
    ds_read_b64_tr_b16 v[236:237], v11 offset:0
    ds_read_b64_tr_b16 v[238:239], v11 offset:2048
    buffer_load_dwordx4 v[36:39], v30, s[28:31], s50 offen offset:1024 sc1
    s_waitcnt lgkmcnt(6)
    v_mfma_f32_32x32x16_bf16 v[176:191], v[208:211], v[72:75], v[176:191]
    ds_read_b128 v[204:207], v7 offset:0
    ds_read_b64_tr_b16 v[240:241], v12 offset:0
    ds_read_b64_tr_b16 v[242:243], v12 offset:2048
    buffer_load_dwordx4 v[40:43], v30, s[28:31], s50 offen offset:2048 sc1
    s_waitcnt lgkmcnt(8)
    v_mfma_f32_32x32x16_bf16 v[176:191], v[212:215], v[76:79], v[176:191]
    ds_read_b128 v[208:211], v8 offset:0
    ds_read_b64_tr_b16 v[244:245], v13 offset:0
    ds_read_b64_tr_b16 v[246:247], v13 offset:2048
    buffer_load_dwordx4 v[44:47], v30, s[28:31], s50 offen offset:3072 sc1
    s_waitcnt lgkmcnt(8)
    v_mfma_f32_32x32x16_bf16 v[176:191], v[200:203], v[80:83], v[176:191]
    ds_read_b128 v[212:215], v9 offset:0
    buffer_load_dwordx4 v[48:51], v30, s[28:31], s51 offen offset:0 sc1
    s_waitcnt lgkmcnt(6)
    v_mfma_f32_32x32x16_bf16 v[176:191], v[204:207], v[84:87], v[176:191]
    ds_read_b64_tr_b16 v[200:201], v10 offset:4096
    ds_read_b64_tr_b16 v[202:203], v10 offset:6144
    buffer_load_dwordx4 v[52:55], v30, s[28:31], s51 offen offset:1024 sc1
    s_waitcnt lgkmcnt(5)
    v_mfma_f32_32x32x16_bf16 v[176:191], v[208:211], v[88:91], v[176:191]
    ds_read_b64_tr_b16 v[204:205], v11 offset:4096
    ds_read_b64_tr_b16 v[206:207], v11 offset:6144
    buffer_load_dwordx4 v[56:59], v30, s[28:31], s51 offen offset:2048 sc1
    s_waitcnt lgkmcnt(4)
    v_mfma_f32_32x32x16_bf16 v[176:191], v[212:215], v[92:95], v[176:191]
    ds_read_b64_tr_b16 v[208:209], v12 offset:4096
    ds_read_b64_tr_b16 v[210:211], v12 offset:6144
    buffer_load_dwordx4 v[60:63], v30, s[28:31], s51 offen offset:3072 sc1
    s_nop 1
    ds_read_b64_tr_b16 v[212:213], v13 offset:4096
    ds_read_b64_tr_b16 v[214:215], v13 offset:6144
    s_nop 7
L_sm15:
    v_exp_f32 v22, v176
    v_exp_f32 v23, v177
    s_nop 0
    v_add_f32 v20, v22, v23
    v_cvt_pk_bf16_f32 v192, v22, v23
    v_exp_f32 v24, v178
    v_exp_f32 v25, v179
    v_add_f32 v20, v20, v24
    v_add_f32 v20, v20, v25
    v_cvt_pk_bf16_f32 v193, v24, v25
    v_exp_f32 v22, v180
    v_exp_f32 v23, v181
    v_add_f32 v20, v20, v22
    v_add_f32 v20, v20, v23
    v_cvt_pk_bf16_f32 v194, v22, v23
    v_exp_f32 v24, v182
    v_exp_f32 v25, v183
    v_add_f32 v20, v20, v24
    v_add_f32 v20, v20, v25
    v_cvt_pk_bf16_f32 v195, v24, v25
    v_exp_f32 v22, v184
    v_exp_f32 v23, v185
    v_add_f32 v20, v20, v22
    v_add_f32 v20, v20, v23
    v_cvt_pk_bf16_f32 v196, v22, v23
    v_exp_f32 v24, v186
    v_exp_f32 v25, v187
    v_add_f32 v20, v20, v24
    v_add_f32 v20, v20, v25
    v_cvt_pk_bf16_f32 v197, v24, v25
    v_exp_f32 v22, v188
    v_exp_f32 v23, v189
    v_add_f32 v20, v20, v22
    v_add_f32 v20, v20, v23
    v_cvt_pk_bf16_f32 v198, v22, v23
    v_exp_f32 v24, v190
    v_exp_f32 v25, v191
    v_add_f32 v20, v20, v24
    v_add_f32 v20, v20, v25
    v_cvt_pk_bf16_f32 v199, v24, v25
    v_cmp_lt_f32 vcc, s43, v20
    s_mov_b32 s41, 15
    s_cbranch_vccnz L_rare
    v_add_f32 v19, v19, v20
    v_mov_b32 v21, v19
    s_nop 1
    v_permlane32_swap_b32 v19, v21
    v_add_f32 v19, v19, v21
    ds_write_b32 v29, v160
    ds_write_b32 v29, v19 offset:4
    v_mfma_f32_32x32x16_bf16 v[96:111], v[232:235], v[192:195], v[96:111]
    v_mfma_f32_32x32x16_bf16 v[112:127], v[236:239], v[192:195], v[112:127]
    buffer_load_dwordx4 v[64:67], v30, s[28:31], s52 offen offset:0 sc1
    v_mfma_f32_32x32x16_bf16 v[128:143], v[240:243], v[192:195], v[128:143]
    buffer_load_dwordx4 v[68:71], v30, s[28:31], s52 offen offset:1024 sc1
    v_mfma_f32_32x32x16_bf16 v[144:159], v[244:247], v[192:195], v[144:159]
    buffer_load_dwordx4 v[72:75], v30, s[28:31], s52 offen offset:2048 sc1
    s_waitcnt lgkmcnt(8)
    v_mfma_f32_32x32x16_bf16 v[96:111], v[200:203], v[196:199], v[96:111]
    buffer_load_dwordx4 v[76:79], v30, s[28:31], s52 offen offset:3072 sc1
    s_waitcnt lgkmcnt(6)
    v_mfma_f32_32x32x16_bf16 v[112:127], v[204:207], v[196:199], v[112:127]
    s_waitcnt lgkmcnt(4)
    v_mfma_f32_32x32x16_bf16 v[128:143], v[208:211], v[196:199], v[128:143]
    s_waitcnt lgkmcnt(2)
    v_mfma_f32_32x32x16_bf16 v[144:159], v[212:215], v[196:199], v[144:159]
    s_waitcnt lgkmcnt(0)
    s_barrier
    ds_read_b64 v[20:21], v28
    v_add_u32 v2, 0xffff4000, v10
    v_add_u32 v6, 16384, v10
    v_add_u32 v10, 49152, v10
    v_add_u32 v3, 0xffff4000, v11
    v_add_u32 v7, 16384, v11
    v_add_u32 v11, 49152, v11
    v_add_u32 v4, 0xffff4000, v12
    v_add_u32 v8, 16384, v12
    v_add_u32 v12, 49152, v12
    v_add_u32 v5, 0xffff4000, v13
    v_add_u32 v9, 16384, v13
    v_add_u32 v13, 49152, v13
    s_waitcnt lgkmcnt(0)
    v_min_f32 v22, v160, v20
    v_sub_f32 v23, v22, v160
    v_sub_f32 v24, v22, v20
    v_exp_f32 v23, v23
    v_exp_f32 v24, v24
    s_nop 0
    v_mul_f32 v25, v19, v23
    v_fma_f32 v25, v21, v24, v25
    v_rcp_f32 v25, v25
    s_nop 0
    v_mul_f32 v24, v23, v25
    v_mul_f32 v25, v23, v25

    s_cmp_eq_u32 s4, 0
    s_cbranch_scc0 R1_22
    v_pk_mul_f32 v[128:129], v[128:129], v[24:25]
    v_pk_mul_f32 v[130:131], v[130:131], v[24:25]
    ds_write_b128 v28, v[128:131] offset:0
    v_pk_mul_f32 v[132:133], v[132:133], v[24:25]
    v_pk_mul_f32 v[134:135], v[134:135], v[24:25]
    ds_write_b128 v28, v[132:135] offset:1024
    v_pk_mul_f32 v[136:137], v[136:137], v[24:25]
    v_pk_mul_f32 v[138:139], v[138:139], v[24:25]
    ds_write_b128 v28, v[136:139] offset:2048
    v_pk_mul_f32 v[140:141], v[140:141], v[24:25]
    v_pk_mul_f32 v[142:143], v[142:143], v[24:25]
    ds_write_b128 v28, v[140:143] offset:3072
    v_pk_mul_f32 v[144:145], v[144:145], v[24:25]
    v_pk_mul_f32 v[146:147], v[146:147], v[24:25]
    ds_write_b128 v28, v[144:147] offset:4096
    v_pk_mul_f32 v[148:149], v[148:149], v[24:25]
    v_pk_mul_f32 v[150:151], v[150:151], v[24:25]
    ds_write_b128 v28, v[148:151] offset:5120
    v_pk_mul_f32 v[152:153], v[152:153], v[24:25]
    v_pk_mul_f32 v[154:155], v[154:155], v[24:25]
    ds_write_b128 v28, v[152:155] offset:6144
    v_pk_mul_f32 v[156:157], v[156:157], v[24:25]
    v_pk_mul_f32 v[158:159], v[158:159], v[24:25]
    ds_write_b128 v28, v[156:159] offset:7168
    s_add_u32 m0, s45, 0
    s_add_u32 s32, s48, 0
    buffer_load_dwordx4 v18, s[12:15], s32 offen lds
    s_add_u32 m0, s45, 8192
    s_add_u32 s32, s48, 65536
    buffer_load_dwordx4 v18, s[12:15], s32 offen lds
    s_add_u32 m0, s45, 49152
    s_add_u32 s32, s48, 32768
    buffer_load_dwordx4 v18, s[12:15], s32 offen lds
    s_add_u32 m0, s45, 57344
    s_add_u32 s32, s48, 98304
    buffer_load_dwordx4 v18, s[12:15], s32 offen lds
    s_waitcnt lgkmcnt(0)
    s_barrier
    ds_read_b128 v[200:203], v29 offset:0
    ds_read_b128 v[204:207], v29 offset:1024
    ds_read_b128 v[208:211], v29 offset:2048
    ds_read_b128 v[212:215], v29 offset:3072
    ds_read_b128 v[232:235], v29 offset:4096
    ds_read_b128 v[236:239], v29 offset:5120
    ds_read_b128 v[240:243], v29 offset:6144
    ds_read_b128 v[244:247], v29 offset:7168
    s_waitcnt lgkmcnt(7)
    v_pk_fma_f32 v[96:97], v[96:97], v[24:25], v[200:201]
    v_pk_fma_f32 v[98:99], v[98:99], v[24:25], v[202:203]
    v_cvt_pk_bf16_f32 v160, v96, v97
    v_cvt_pk_bf16_f32 v161, v98, v99
    s_waitcnt lgkmcnt(6)
    v_pk_fma_f32 v[100:101], v[100:101], v[24:25], v[204:205]
    v_pk_fma_f32 v[102:103], v[102:103], v[24:25], v[206:207]
    v_cvt_pk_bf16_f32 v162, v100, v101
    v_cvt_pk_bf16_f32 v163, v102, v103
    s_waitcnt lgkmcnt(5)
    v_pk_fma_f32 v[104:105], v[104:105], v[24:25], v[208:209]
    v_pk_fma_f32 v[106:107], v[106:107], v[24:25], v[210:211]
    v_cvt_pk_bf16_f32 v164, v104, v105
    v_cvt_pk_bf16_f32 v165, v106, v107
    s_waitcnt lgkmcnt(4)
    v_pk_fma_f32 v[108:109], v[108:109], v[24:25], v[212:213]
    v_pk_fma_f32 v[110:111], v[110:111], v[24:25], v[214:215]
    v_cvt_pk_bf16_f32 v166, v108, v109
    v_cvt_pk_bf16_f32 v167, v110, v111
    s_add_u32 s34, s42, 32768
    buffer_store_dwordx4 v[160:163], v30, s[28:31], s34 offen sc1
    s_add_u32 s34, s42, 33792
    buffer_store_dwordx4 v[164:167], v30, s[28:31], s34 offen sc1
    s_waitcnt lgkmcnt(3)
    v_pk_fma_f32 v[112:113], v[112:113], v[24:25], v[232:233]
    v_pk_fma_f32 v[114:115], v[114:115], v[24:25], v[234:235]
    v_cvt_pk_bf16_f32 v168, v112, v113
    v_cvt_pk_bf16_f32 v169, v114, v115
    s_waitcnt lgkmcnt(2)
    v_pk_fma_f32 v[116:117], v[116:117], v[24:25], v[236:237]
    v_pk_fma_f32 v[118:119], v[118:119], v[24:25], v[238:239]
    v_cvt_pk_bf16_f32 v170, v116, v117
    v_cvt_pk_bf16_f32 v171, v118, v119
    s_waitcnt lgkmcnt(1)
    v_pk_fma_f32 v[120:121], v[120:121], v[24:25], v[240:241]
    v_pk_fma_f32 v[122:123], v[122:123], v[24:25], v[242:243]
    v_cvt_pk_bf16_f32 v172, v120, v121
    v_cvt_pk_bf16_f32 v173, v122, v123
    s_waitcnt lgkmcnt(0)
    v_pk_fma_f32 v[124:125], v[124:125], v[24:25], v[244:245]
    v_pk_fma_f32 v[126:127], v[126:127], v[24:25], v[246:247]
    v_cvt_pk_bf16_f32 v174, v124, v125
    v_cvt_pk_bf16_f32 v175, v126, v127
    s_add_u32 s34, s42, 34816
    buffer_store_dwordx4 v[168:171], v30, s[28:31], s34 offen sc1
    s_add_u32 s34, s42, 35840
    buffer_store_dwordx4 v[172:175], v30, s[28:31], s34 offen sc1
    s_branch RE_23
R1_22:
    v_pk_mul_f32 v[96:97], v[96:97], v[24:25]
    v_pk_mul_f32 v[98:99], v[98:99], v[24:25]
    ds_write_b128 v28, v[96:99] offset:0
    v_pk_mul_f32 v[100:101], v[100:101], v[24:25]
    v_pk_mul_f32 v[102:103], v[102:103], v[24:25]
    ds_write_b128 v28, v[100:103] offset:1024
    v_pk_mul_f32 v[104:105], v[104:105], v[24:25]
    v_pk_mul_f32 v[106:107], v[106:107], v[24:25]
    ds_write_b128 v28, v[104:107] offset:2048
    v_pk_mul_f32 v[108:109], v[108:109], v[24:25]
    v_pk_mul_f32 v[110:111], v[110:111], v[24:25]
    ds_write_b128 v28, v[108:111] offset:3072
    v_pk_mul_f32 v[112:113], v[112:113], v[24:25]
    v_pk_mul_f32 v[114:115], v[114:115], v[24:25]
    ds_write_b128 v28, v[112:115] offset:4096
    v_pk_mul_f32 v[116:117], v[116:117], v[24:25]
    v_pk_mul_f32 v[118:119], v[118:119], v[24:25]
    ds_write_b128 v28, v[116:119] offset:5120
    v_pk_mul_f32 v[120:121], v[120:121], v[24:25]
    v_pk_mul_f32 v[122:123], v[122:123], v[24:25]
    ds_write_b128 v28, v[120:123] offset:6144
    v_pk_mul_f32 v[124:125], v[124:125], v[24:25]
    v_pk_mul_f32 v[126:127], v[126:127], v[24:25]
    ds_write_b128 v28, v[124:127] offset:7168
    s_add_u32 m0, s45, 0
    s_add_u32 s32, s48, 0
    buffer_load_dwordx4 v18, s[12:15], s32 offen lds
    s_add_u32 m0, s45, 8192
    s_add_u32 s32, s48, 65536
    buffer_load_dwordx4 v18, s[12:15], s32 offen lds
    s_add_u32 m0, s45, 49152
    s_add_u32 s32, s48, 32768
    buffer_load_dwordx4 v18, s[12:15], s32 offen lds
    s_add_u32 m0, s45, 57344
    s_add_u32 s32, s48, 98304
    buffer_load_dwordx4 v18, s[12:15], s32 offen lds
    s_waitcnt lgkmcnt(0)
    s_barrier
    ds_read_b128 v[200:203], v29 offset:0
    ds_read_b128 v[204:207], v29 offset:1024
    ds_read_b128 v[208:211], v29 offset:2048
    ds_read_b128 v[212:215], v29 offset:3072
    ds_read_b128 v[232:235], v29 offset:4096
    ds_read_b128 v[236:239], v29 offset:5120
    ds_read_b128 v[240:243], v29 offset:6144
    ds_read_b128 v[244:247], v29 offset:7168
    s_waitcnt lgkmcnt(7)
    v_pk_fma_f32 v[128:129], v[128:129], v[24:25], v[200:201]
    v_pk_fma_f32 v[130:131], v[130:131], v[24:25], v[202:203]
    v_cvt_pk_bf16_f32 v160, v128, v129
    v_cvt_pk_bf16_f32 v161, v130, v131
    s_waitcnt lgkmcnt(6)
    v_pk_fma_f32 v[132:133], v[132:133], v[24:25], v[204:205]
    v_pk_fma_f32 v[134:135], v[134:135], v[24:25], v[206:207]
    v_cvt_pk_bf16_f32 v162, v132, v133
    v_cvt_pk_bf16_f32 v163, v134, v135
    s_waitcnt lgkmcnt(5)
    v_pk_fma_f32 v[136:137], v[136:137], v[24:25], v[208:209]
    v_pk_fma_f32 v[138:139], v[138:139], v[24:25], v[210:211]
    v_cvt_pk_bf16_f32 v164, v136, v137
    v_cvt_pk_bf16_f32 v165, v138, v139
    s_waitcnt lgkmcnt(4)
    v_pk_fma_f32 v[140:141], v[140:141], v[24:25], v[212:213]
    v_pk_fma_f32 v[142:143], v[142:143], v[24:25], v[214:215]
    v_cvt_pk_bf16_f32 v166, v140, v141
    v_cvt_pk_bf16_f32 v167, v142, v143
    s_add_u32 s34, s42, 36864
    buffer_store_dwordx4 v[160:163], v30, s[28:31], s34 offen sc1
    s_add_u32 s34, s42, 37888
    buffer_store_dwordx4 v[164:167], v30, s[28:31], s34 offen sc1
    s_waitcnt lgkmcnt(3)
    v_pk_fma_f32 v[144:145], v[144:145], v[24:25], v[232:233]
    v_pk_fma_f32 v[146:147], v[146:147], v[24:25], v[234:235]
    v_cvt_pk_bf16_f32 v168, v144, v145
    v_cvt_pk_bf16_f32 v169, v146, v147
    s_waitcnt lgkmcnt(2)
    v_pk_fma_f32 v[148:149], v[148:149], v[24:25], v[236:237]
    v_pk_fma_f32 v[150:151], v[150:151], v[24:25], v[238:239]
    v_cvt_pk_bf16_f32 v170, v148, v149
    v_cvt_pk_bf16_f32 v171, v150, v151
    s_waitcnt lgkmcnt(1)
    v_pk_fma_f32 v[152:153], v[152:153], v[24:25], v[240:241]
    v_pk_fma_f32 v[154:155], v[154:155], v[24:25], v[242:243]
    v_cvt_pk_bf16_f32 v172, v152, v153
    v_cvt_pk_bf16_f32 v173, v154, v155
    s_waitcnt lgkmcnt(0)
    v_pk_fma_f32 v[156:157], v[156:157], v[24:25], v[244:245]
    v_pk_fma_f32 v[158:159], v[158:159], v[24:25], v[246:247]
    v_cvt_pk_bf16_f32 v174, v156, v157
    v_cvt_pk_bf16_f32 v175, v158, v159
    s_add_u32 s34, s42, 38912
    buffer_store_dwordx4 v[168:171], v30, s[28:31], s34 offen sc1
    s_add_u32 s34, s42, 39936
    buffer_store_dwordx4 v[172:175], v30, s[28:31], s34 offen sc1
RE_23:
    s_nop 1
    ds_read_b64_tr_b16 v[176:177], v10 offset:0
    ds_read_b64_tr_b16 v[178:179], v10 offset:2048
    ds_read_b64_tr_b16 v[180:181], v11 offset:0
    ds_read_b64_tr_b16 v[182:183], v11 offset:2048
    ds_read_b64_tr_b16 v[184:185], v12 offset:0
    ds_read_b64_tr_b16 v[186:187], v12 offset:2048
    ds_read_b64_tr_b16 v[188:189], v13 offset:0
    ds_read_b64_tr_b16 v[190:191], v13 offset:2048
    s_waitcnt vmcnt(19)
    s_waitcnt lgkmcnt(6)
    v_mfma_f32_32x32x16_bf16 v[96:111], v[176:179], v[32:35], 0
    ds_read_b64_tr_b16 v[192:193], v10 offset:4096
    ds_read_b64_tr_b16 v[194:195], v10 offset:6144
    s_waitcnt lgkmcnt(6)
    v_mfma_f32_32x32x16_bf16 v[112:127], v[180:183], v[32:35], 0
    ds_read_b64_tr_b16 v[196:197], v11 offset:4096
    ds_read_b64_tr_b16 v[198:199], v11 offset:6144
    s_waitcnt lgkmcnt(6)
    v_mfma_f32_32x32x16_bf16 v[128:143], v[184:187], v[32:35], 0
    ds_read_b64_tr_b16 v[200:201], v12 offset:4096
    ds_read_b64_tr_b16 v[202:203], v12 offset:6144
    s_waitcnt lgkmcnt(6)
    v_mfma_f32_32x32x16_bf16 v[144:159], v[188:191], v[32:35], 0
    ds_read_b64_tr_b16 v[204:205], v13 offset:4096
    ds_read_b64_tr_b16 v[206:207], v13 offset:6144
    s_waitcnt vmcnt(18)
    s_waitcnt lgkmcnt(6)
    v_mfma_f32_32x32x16_bf16 v[96:111], v[192:195], v[36:39], v[96:111]
    ds_read_b64_tr_b16 v[176:177], v10 offset:16384
    ds_read_b64_tr_b16 v[178:179], v10 offset:18432
    s_waitcnt lgkmcnt(6)
    v_mfma_f32_32x32x16_bf16 v[112:127], v[196:199], v[36:39], v[112:127]
    ds_read_b64_tr_b16 v[180:181], v11 offset:16384
    ds_read_b64_tr_b16 v[182:183], v11 offset:18432
    s_waitcnt lgkmcnt(6)
    v_mfma_f32_32x32x16_bf16 v[128:143], v[200:203], v[36:39], v[128:143]
    ds_read_b64_tr_b16 v[184:185], v12 offset:16384
    ds_read_b64_tr_b16 v[186:187], v12 offset:18432
    s_waitcnt lgkmcnt(6)
    v_mfma_f32_32x32x16_bf16 v[144:159], v[204:207], v[36:39], v[144:159]
    ds_read_b64_tr_b16 v[188:189], v13 offset:16384
    ds_read_b64_tr_b16 v[190:191], v13 offset:18432
    s_waitcnt vmcnt(17)
    s_waitcnt lgkmcnt(6)
    v_mfma_f32_32x32x16_bf16 v[96:111], v[176:179], v[40:43], v[96:111]
    ds_read_b64_tr_b16 v[192:193], v10 offset:20480
    ds_read_b64_tr_b16 v[194:195], v10 offset:22528
    s_waitcnt lgkmcnt(6)
    v_mfma_f32_32x32x16_bf16 v[112:127], v[180:183], v[40:43], v[112:127]
    ds_read_b64_tr_b16 v[196:197], v11 offset:20480
    ds_read_b64_tr_b16 v[198:199], v11 offset:22528
    s_waitcnt lgkmcnt(6)
    v_mfma_f32_32x32x16_bf16 v[128:143], v[184:187], v[40:43], v[128:143]
    ds_read_b64_tr_b16 v[200:201], v12 offset:20480
    ds_read_b64_tr_b16 v[202:203], v12 offset:22528
    s_waitcnt lgkmcnt(6)
    v_mfma_f32_32x32x16_bf16 v[144:159], v[188:191], v[40:43], v[144:159]
    ds_read_b64_tr_b16 v[204:205], v13 offset:20480
    ds_read_b64_tr_b16 v[206:207], v13 offset:22528
    s_waitcnt vmcnt(16)
    s_waitcnt lgkmcnt(6)
    v_mfma_f32_32x32x16_bf16 v[96:111], v[192:195], v[44:47], v[96:111]
    ds_read_b64_tr_b16 v[176:177], v10 offset:32768
    ds_read_b64_tr_b16 v[178:179], v10 offset:34816
    s_waitcnt lgkmcnt(6)
    v_mfma_f32_32x32x16_bf16 v[112:127], v[196:199], v[44:47], v[112:127]
    ds_read_b64_tr_b16 v[180:181], v11 offset:32768
    ds_read_b64_tr_b16 v[182:183], v11 offset:34816
    s_waitcnt lgkmcnt(6)
    v_mfma_f32_32x32x16_bf16 v[128:143], v[200:203], v[44:47], v[128:143]
    ds_read_b64_tr_b16 v[184:185], v12 offset:32768
    ds_read_b64_tr_b16 v[186:187], v12 offset:34816
    s_waitcnt lgkmcnt(6)
    v_mfma_f32_32x32x16_bf16 v[144:159], v[204:207], v[44:47], v[144:159]
    ds_read_b64_tr_b16 v[188:189], v13 offset:32768
    ds_read_b64_tr_b16 v[190:191], v13 offset:34816
    s_waitcnt vmcnt(0)
    s_barrier
    s_cmp_eq_u32 s3, 7
    s_cbranch_scc0 nf_24
    v_mov_b32 v254, 0
    v_mov_b32 v255, 1
    s_mov_b64 exec, 1
    buffer_store_dword v255, v254, s[88:91], s75 offen offset:4 sc1
    s_mov_b64 exec, -1
nf_24:

    s_waitcnt lgkmcnt(6)
    v_mfma_f32_32x32x16_bf16 v[96:111], v[176:179], v[48:51], v[96:111]
    ds_read_b64_tr_b16 v[192:193], v10 offset:36864
    ds_read_b64_tr_b16 v[194:195], v10 offset:38912
    s_add_u32 m0, s45, 16384
    s_add_u32 s32, s49, 0
    buffer_load_dwordx4 v18, s[12:15], s32 offen lds
    s_waitcnt lgkmcnt(6)
    v_mfma_f32_32x32x16_bf16 v[112:127], v[180:183], v[48:51], v[112:127]
    ds_read_b64_tr_b16 v[196:197], v11 offset:36864
    ds_read_b64_tr_b16 v[198:199], v11 offset:38912
    s_add_u32 m0, s45, 24576
    s_add_u32 s32, s49, 65536
    buffer_load_dwordx4 v18, s[12:15], s32 offen lds
    s_waitcnt lgkmcnt(6)
    v_mfma_f32_32x32x16_bf16 v[128:143], v[184:187], v[48:51], v[128:143]
    ds_read_b64_tr_b16 v[200:201], v12 offset:36864
    ds_read_b64_tr_b16 v[202:203], v12 offset:38912
    s_add_u32 m0, s45, 32768
    s_add_u32 s32, s49, 32768
    buffer_load_dwordx4 v18, s[12:15], s32 offen lds
    s_waitcnt lgkmcnt(6)
    v_mfma_f32_32x32x16_bf16 v[144:159], v[188:191], v[48:51], v[144:159]
    ds_read_b64_tr_b16 v[204:205], v13 offset:36864
    ds_read_b64_tr_b16 v[206:207], v13 offset:38912
    s_waitcnt lgkmcnt(6)
    v_mfma_f32_32x32x16_bf16 v[96:111], v[192:195], v[52:55], v[96:111]
    ds_read_b64_tr_b16 v[176:177], v10 offset:49152
    ds_read_b64_tr_b16 v[178:179], v10 offset:51200
    s_add_u32 m0, s45, 40960
    s_add_u32 s32, s49, 98304
    buffer_load_dwordx4 v18, s[12:15], s32 offen lds
    s_waitcnt lgkmcnt(6)
    v_mfma_f32_32x32x16_bf16 v[112:127], v[196:199], v[52:55], v[112:127]
    ds_read_b64_tr_b16 v[180:181], v11 offset:49152
    ds_read_b64_tr_b16 v[182:183], v11 offset:51200
    s_add_u32 m0, s45, 65536
    s_add_u32 s32, s49, 524288
    buffer_load_dwordx4 v18, s[12:15], s32 offen lds
    s_waitcnt lgkmcnt(6)
    v_mfma_f32_32x32x16_bf16 v[128:143], v[200:203], v[52:55], v[128:143]
    ds_read_b64_tr_b16 v[184:185], v12 offset:49152
    ds_read_b64_tr_b16 v[186:187], v12 offset:51200
    s_add_u32 m0, s45, 73728
    s_add_u32 s32, s49, 589824
    buffer_load_dwordx4 v18, s[12:15], s32 offen lds
    s_waitcnt lgkmcnt(6)
    v_mfma_f32_32x32x16_bf16 v[144:159], v[204:207], v[52:55], v[144:159]
    ds_read_b64_tr_b16 v[188:189], v13 offset:49152
    ds_read_b64_tr_b16 v[190:191], v13 offset:51200
    s_waitcnt lgkmcnt(6)
    v_mfma_f32_32x32x16_bf16 v[96:111], v[176:179], v[56:59], v[96:111]
    ds_read_b64_tr_b16 v[192:193], v10 offset:53248
    ds_read_b64_tr_b16 v[194:195], v10 offset:55296
    s_add_u32 m0, s45, 81920
    s_add_u32 s32, s49, 557056
    buffer_load_dwordx4 v18, s[12:15], s32 offen lds
    s_waitcnt lgkmcnt(6)
    v_mfma_f32_32x32x16_bf16 v[112:127], v[180:183], v[56:59], v[112:127]
    ds_read_b64_tr_b16 v[196:197], v11 offset:53248
    ds_read_b64_tr_b16 v[198:199], v11 offset:55296
    s_add_u32 m0, s45, 90112
    s_add_u32 s32, s49, 622592
    buffer_load_dwordx4 v18, s[12:15], s32 offen lds
    s_waitcnt lgkmcnt(6)
    v_mfma_f32_32x32x16_bf16 v[128:143], v[184:187], v[56:59], v[128:143]
    ds_read_b64_tr_b16 v[200:201], v12 offset:53248
    ds_read_b64_tr_b16 v[202:203], v12 offset:55296
    s_waitcnt lgkmcnt(6)
    v_mfma_f32_32x32x16_bf16 v[144:159], v[188:191], v[56:59], v[144:159]
    ds_read_b64_tr_b16 v[204:205], v13 offset:53248
    ds_read_b64_tr_b16 v[206:207], v13 offset:55296
    s_waitcnt lgkmcnt(6)
    v_mfma_f32_32x32x16_bf16 v[96:111], v[192:195], v[60:63], v[96:111]
    ds_read_b64_tr_b16 v[176:177], v2 offset:0
    ds_read_b64_tr_b16 v[178:179], v2 offset:2048
    s_waitcnt lgkmcnt(6)
    v_mfma_f32_32x32x16_bf16 v[112:127], v[196:199], v[60:63], v[112:127]
    ds_read_b64_tr_b16 v[180:181], v3 offset:0
    ds_read_b64_tr_b16 v[182:183], v3 offset:2048
    s_waitcnt lgkmcnt(6)
    v_mfma_f32_32x32x16_bf16 v[128:143], v[200:203], v[60:63], v[128:143]
    ds_read_b64_tr_b16 v[184:185], v4 offset:0
    ds_read_b64_tr_b16 v[186:187], v4 offset:2048
    s_waitcnt lgkmcnt(6)
    v_mfma_f32_32x32x16_bf16 v[144:159], v[204:207], v[60:63], v[144:159]
    ds_read_b64_tr_b16 v[188:189], v5 offset:0
    ds_read_b64_tr_b16 v[190:191], v5 offset:2048
    s_waitcnt lgkmcnt(6)
    v_mfma_f32_32x32x16_bf16 v[96:111], v[176:179], v[64:67], v[96:111]
    ds_read_b64_tr_b16 v[192:193], v2 offset:4096
    ds_read_b64_tr_b16 v[194:195], v2 offset:6144
    s_waitcnt lgkmcnt(6)
    v_mfma_f32_32x32x16_bf16 v[112:127], v[180:183], v[64:67], v[112:127]
    ds_read_b64_tr_b16 v[196:197], v3 offset:4096
    ds_read_b64_tr_b16 v[198:199], v3 offset:6144
    s_waitcnt lgkmcnt(6)
    v_mfma_f32_32x32x16_bf16 v[128:143], v[184:187], v[64:67], v[128:143]
    ds_read_b64_tr_b16 v[200:201], v4 offset:4096
    ds_read_b64_tr_b16 v[202:203], v4 offset:6144
    s_waitcnt lgkmcnt(6)
    v_mfma_f32_32x32x16_bf16 v[144:159], v[188:191], v[64:67], v[144:159]
    ds_read_b64_tr_b16 v[204:205], v5 offset:4096
    ds_read_b64_tr_b16 v[206:207], v5 offset:6144
    s_waitcnt lgkmcnt(6)
    v_mfma_f32_32x32x16_bf16 v[96:111], v[192:195], v[68:71], v[96:111]
    ds_read_b64_tr_b16 v[176:177], v2 offset:49152
    ds_read_b64_tr_b16 v[178:179], v2 offset:51200
    s_waitcnt lgkmcnt(6)
    v_mfma_f32_32x32x16_bf16 v[112:127], v[196:199], v[68:71], v[112:127]
    ds_read_b64_tr_b16 v[180:181], v3 offset:49152
    ds_read_b64_tr_b16 v[182:183], v3 offset:51200
    s_waitcnt lgkmcnt(6)
    v_mfma_f32_32x32x16_bf16 v[128:143], v[200:203], v[68:71], v[128:143]
    ds_read_b64_tr_b16 v[184:185], v4 offset:49152
    ds_read_b64_tr_b16 v[186:187], v4 offset:51200
    s_waitcnt lgkmcnt(6)
    v_mfma_f32_32x32x16_bf16 v[144:159], v[204:207], v[68:71], v[144:159]
    ds_read_b64_tr_b16 v[188:189], v5 offset:49152
    ds_read_b64_tr_b16 v[190:191], v5 offset:51200
    s_waitcnt lgkmcnt(6)
    v_mfma_f32_32x32x16_bf16 v[96:111], v[176:179], v[72:75], v[96:111]
    ds_read_b64_tr_b16 v[192:193], v2 offset:53248
    ds_read_b64_tr_b16 v[194:195], v2 offset:55296
    s_cmp_eq_u32 s3, 0
    s_cbranch_scc0 si_25
    buffer_load_dword v251, v248, s[88:91], s54 offen offset:4 sc1
si_25:
    s_waitcnt lgkmcnt(6)
    v_mfma_f32_32x32x16_bf16 v[112:127], v[180:183], v[72:75], v[112:127]
    ds_read_b64_tr_b16 v[196:197], v3 offset:53248
    ds_read_b64_tr_b16 v[198:199], v3 offset:55296
    s_waitcnt lgkmcnt(6)
    v_mfma_f32_32x32x16_bf16 v[128:143], v[184:187], v[72:75], v[128:143]
    ds_read_b64_tr_b16 v[200:201], v4 offset:53248
    ds_read_b64_tr_b16 v[202:203], v4 offset:55296
    s_waitcnt lgkmcnt(6)
    v_mfma_f32_32x32x16_bf16 v[144:159], v[188:191], v[72:75], v[144:159]
    ds_read_b64_tr_b16 v[204:205], v5 offset:53248
    ds_read_b64_tr_b16 v[206:207], v5 offset:55296
    s_waitcnt vmcnt(0)
    s_waitcnt lgkmcnt(0)
    s_barrier
    v_mfma_f32_32x32x16_bf16 v[96:111], v[192:195], v[76:79], v[96:111]
    ds_read_b64_tr_b16 v[176:177], v2 offset:16384
    ds_read_b64_tr_b16 v[178:179], v2 offset:18432
    s_add_u32 m0, s45, 98304
    s_add_u32 s32, s46, 524288
    buffer_load_dwordx4 v18, s[12:15], s32 offen lds
    v_mfma_f32_32x32x16_bf16 v[112:127], v[196:199], v[76:79], v[112:127]
    ds_read_b64_tr_b16 v[180:181], v3 offset:16384
    ds_read_b64_tr_b16 v[182:183], v3 offset:18432
    s_add_u32 m0, s45, 106496
    s_add_u32 s32, s46, 589824
    buffer_load_dwordx4 v18, s[12:15], s32 offen lds
    v_mfma_f32_32x32x16_bf16 v[128:143], v[200:203], v[76:79], v[128:143]
    ds_read_b64_tr_b16 v[184:185], v4 offset:16384
    ds_read_b64_tr_b16 v[186:187], v4 offset:18432
    s_add_u32 m0, s45, 114688
    s_add_u32 s32, s46, 557056
    buffer_load_dwordx4 v18, s[12:15], s32 offen lds
    v_mfma_f32_32x32x16_bf16 v[144:159], v[204:207], v[76:79], v[144:159]
    ds_read_b64_tr_b16 v[188:189], v5 offset:16384
    ds_read_b64_tr_b16 v[190:191], v5 offset:18432
    s_waitcnt lgkmcnt(6)
    v_mfma_f32_32x32x16_bf16 v[96:111], v[176:179], v[216:219], v[96:111]
    ds_read_b64_tr_b16 v[192:193], v2 offset:20480
    ds_read_b64_tr_b16 v[194:195], v2 offset:22528
    s_add_u32 m0, s45, 122880
    s_add_u32 s32, s46, 622592
    buffer_load_dwordx4 v18, s[12:15], s32 offen lds
    s_waitcnt lgkmcnt(6)
    v_mfma_f32_32x32x16_bf16 v[112:127], v[180:183], v[216:219], v[112:127]
    ds_read_b64_tr_b16 v[196:197], v3 offset:20480
    ds_read_b64_tr_b16 v[198:199], v3 offset:22528
    s_add_u32 m0, s45, 131072
    s_add_u32 s32, s47, 524288
    buffer_load_dwordx4 v18, s[12:15], s32 offen lds
    s_waitcnt lgkmcnt(6)
    v_mfma_f32_32x32x16_bf16 v[128:143], v[184:187], v[216:219], v[128:143]
    ds_read_b64_tr_b16 v[200:201], v4 offset:20480
    ds_read_b64_tr_b16 v[202:203], v4 offset:22528
    s_add_u32 m0, s45, 139264
    s_add_u32 s32, s47, 589824
    buffer_load_dwordx4 v18, s[12:15], s32 offen lds
    s_waitcnt lgkmcnt(6)
    v_mfma_f32_32x32x16_bf16 v[144:159], v[188:191], v[216:219], v[144:159]
    ds_read_b64_tr_b16 v[204:205], v5 offset:20480
    ds_read_b64_tr_b16 v[206:207], v5 offset:22528
    s_waitcnt lgkmcnt(6)
    v_mfma_f32_32x32x16_bf16 v[96:111], v[192:195], v[220:223], v[96:111]
    ds_read_b64_tr_b16 v[176:177], v2 offset:32768
    ds_read_b64_tr_b16 v[178:179], v2 offset:34816
    s_add_u32 m0, s45, 147456
    s_add_u32 s32, s47, 557056
    buffer_load_dwordx4 v18, s[12:15], s32 offen lds
    s_waitcnt lgkmcnt(6)
    v_mfma_f32_32x32x16_bf16 v[112:127], v[196:199], v[220:223], v[112:127]
    ds_read_b64_tr_b16 v[180:181], v3 offset:32768
    ds_read_b64_tr_b16 v[182:183], v3 offset:34816
    s_add_u32 m0, s45, 155648
    s_add_u32 s32, s47, 622592
    buffer_load_dwordx4 v18, s[12:15], s32 offen lds
    s_waitcnt lgkmcnt(6)
    v_mfma_f32_32x32x16_bf16 v[128:143], v[200:203], v[220:223], v[128:143]
    ds_read_b64_tr_b16 v[184:185], v4 offset:32768
    ds_read_b64_tr_b16 v[186:187], v4 offset:34816
    s_waitcnt lgkmcnt(6)
    v_mfma_f32_32x32x16_bf16 v[144:159], v[204:207], v[220:223], v[144:159]
    ds_read_b64_tr_b16 v[188:189], v5 offset:32768
    ds_read_b64_tr_b16 v[190:191], v5 offset:34816
    s_cmp_eq_u32 s3, 0
    s_cbranch_scc0 sc_26
    s_waitcnt vmcnt(8)
    s_mov_b32 s35, 0
plp_28:
    v_cmp_ne_u32 vcc, 1, v251
    s_lshl_b32 s34, 1, s82
    s_andn2_b32 s34, vcc_lo, s34
    s_and_b32 s34, s34, 15
    s_cbranch_scc0 pok_27
    s_add_u32 s35, s35, 1
    s_cmp_ge_u32 s35, 50000
    s_cbranch_scc1 pok_27
    buffer_load_dword v251, v248, s[88:91], s54 offen offset:4 sc1
    s_waitcnt vmcnt(0)
    s_branch plp_28
pok_27:
sc_26:
    s_barrier
    s_waitcnt lgkmcnt(6)
    v_mfma_f32_32x32x16_bf16 v[96:111], v[176:179], v[224:227], v[96:111]
    ds_read_b64_tr_b16 v[192:193], v2 offset:36864
    ds_read_b64_tr_b16 v[194:195], v2 offset:38912
    s_add_u32 s34, s50, 32768
    buffer_load_dwordx4 v[32:35], v30, s[28:31], s34 offen offset:0 sc1
    s_waitcnt lgkmcnt(6)
    v_mfma_f32_32x32x16_bf16 v[112:127], v[180:183], v[224:227], v[112:127]
    ds_read_b64_tr_b16 v[196:197], v3 offset:36864
    ds_read_b64_tr_b16 v[198:199], v3 offset:38912
    s_add_u32 s34, s50, 32768
    buffer_load_dwordx4 v[36:39], v30, s[28:31], s34 offen offset:1024 sc1
    s_waitcnt lgkmcnt(6)
    v_mfma_f32_32x32x16_bf16 v[128:143], v[184:187], v[224:227], v[128:143]
    ds_read_b64_tr_b16 v[200:201], v4 offset:36864
    ds_read_b64_tr_b16 v[202:203], v4 offset:38912
    s_add_u32 s34, s50, 32768
    buffer_load_dwordx4 v[40:43], v30, s[28:31], s34 offen offset:2048 sc1
    s_waitcnt lgkmcnt(6)
    v_mfma_f32_32x32x16_bf16 v[144:159], v[188:191], v[224:227], v[144:159]
    ds_read_b64_tr_b16 v[204:205], v5 offset:36864
    ds_read_b64_tr_b16 v[206:207], v5 offset:38912
    s_add_u32 s34, s50, 32768
    buffer_load_dwordx4 v[44:47], v30, s[28:31], s34 offen offset:3072 sc1
    s_waitcnt lgkmcnt(6)
    v_mfma_f32_32x32x16_bf16 v[96:111], v[192:195], v[228:231], v[96:111]
    ds_read_b64_tr_b16 v[176:177], v6 offset:0
    ds_read_b64_tr_b16 v[178:179], v6 offset:2048
    s_add_u32 s34, s51, 32768
    buffer_load_dwordx4 v[48:51], v30, s[28:31], s34 offen offset:0 sc1
    s_waitcnt lgkmcnt(6)
    v_mfma_f32_32x32x16_bf16 v[112:127], v[196:199], v[228:231], v[112:127]
    ds_read_b64_tr_b16 v[180:181], v7 offset:0
    ds_read_b64_tr_b16 v[182:183], v7 offset:2048
    s_add_u32 s34, s51, 32768
    buffer_load_dwordx4 v[52:55], v30, s[28:31], s34 offen offset:1024 sc1
    s_waitcnt lgkmcnt(6)
    v_mfma_f32_32x32x16_bf16 v[128:143], v[200:203], v[228:231], v[128:143]
    ds_read_b64_tr_b16 v[184:185], v8 offset:0
    ds_read_b64_tr_b16 v[186:187], v8 offset:2048
    s_add_u32 s34, s51, 32768
    buffer_load_dwordx4 v[56:59], v30, s[28:31], s34 offen offset:2048 sc1
    s_waitcnt lgkmcnt(6)
    v_mfma_f32_32x32x16_bf16 v[144:159], v[204:207], v[228:231], v[144:159]
    ds_read_b64_tr_b16 v[188:189], v9 offset:0
    ds_read_b64_tr_b16 v[190:191], v9 offset:2048
    s_add_u32 s34, s51, 32768
    buffer_load_dwordx4 v[60:63], v30, s[28:31], s34 offen offset:3072 sc1
    s_waitcnt lgkmcnt(6)
    v_mfma_f32_32x32x16_bf16 v[96:111], v[176:179], v[160:163], v[96:111]
    ds_read_b64_tr_b16 v[192:193], v6 offset:4096
    ds_read_b64_tr_b16 v[194:195], v6 offset:6144
    s_add_u32 s34, s52, 32768
    buffer_load_dwordx4 v[64:67], v30, s[28:31], s34 offen offset:0 sc1
    s_waitcnt lgkmcnt(6)
    v_mfma_f32_32x32x16_bf16 v[112:127], v[180:183], v[160:163], v[112:127]
    ds_read_b64_tr_b16 v[196:197], v7 offset:4096
    ds_read_b64_tr_b16 v[198:199], v7 offset:6144
    s_add_u32 s34, s52, 32768
    buffer_load_dwordx4 v[68:71], v30, s[28:31], s34 offen offset:1024 sc1
    s_waitcnt lgkmcnt(6)
    v_mfma_f32_32x32x16_bf16 v[128:143], v[184:187], v[160:163], v[128:143]
    ds_read_b64_tr_b16 v[200:201], v8 offset:4096
    ds_read_b64_tr_b16 v[202:203], v8 offset:6144
    s_add_u32 s34, s52, 32768
    buffer_load_dwordx4 v[72:75], v30, s[28:31], s34 offen offset:2048 sc1
    s_waitcnt lgkmcnt(6)
    v_mfma_f32_32x32x16_bf16 v[144:159], v[188:191], v[160:163], v[144:159]
    ds_read_b64_tr_b16 v[204:205], v9 offset:4096
    ds_read_b64_tr_b16 v[206:207], v9 offset:6144
    s_add_u32 s34, s52, 32768
    buffer_load_dwordx4 v[76:79], v30, s[28:31], s34 offen offset:3072 sc1
    s_waitcnt lgkmcnt(6)
    v_mfma_f32_32x32x16_bf16 v[96:111], v[192:195], v[164:167], v[96:111]
    ds_read_b64_tr_b16 v[176:177], v6 offset:16384
    ds_read_b64_tr_b16 v[178:179], v6 offset:18432
    s_add_u32 m0, s45, 0
    s_add_u32 s32, s48, 524288
    buffer_load_dwordx4 v18, s[12:15], s32 offen lds
    s_waitcnt lgkmcnt(6)
    v_mfma_f32_32x32x16_bf16 v[112:127], v[196:199], v[164:167], v[112:127]
    ds_read_b64_tr_b16 v[180:181], v7 offset:16384
    ds_read_b64_tr_b16 v[182:183], v7 offset:18432
    s_add_u32 m0, s45, 8192
    s_add_u32 s32, s48, 589824
    buffer_load_dwordx4 v18, s[12:15], s32 offen lds
    s_waitcnt lgkmcnt(6)
    v_mfma_f32_32x32x16_bf16 v[128:143], v[200:203], v[164:167], v[128:143]
    ds_read_b64_tr_b16 v[184:185], v8 offset:16384
    ds_read_b64_tr_b16 v[186:187], v8 offset:18432
    s_add_u32 m0, s45, 49152
    s_add_u32 s32, s48, 557056
    buffer_load_dwordx4 v18, s[12:15], s32 offen lds
    s_waitcnt lgkmcnt(6)
    v_mfma_f32_32x32x16_bf16 v[144:159], v[204:207], v[164:167], v[144:159]
    ds_read_b64_tr_b16 v[188:189], v9 offset:16384
    ds_read_b64_tr_b16 v[190:191], v9 offset:18432
    s_waitcnt lgkmcnt(6)
    v_mfma_f32_32x32x16_bf16 v[96:111], v[176:179], v[168:171], v[96:111]
    ds_read_b64_tr_b16 v[192:193], v6 offset:20480
    ds_read_b64_tr_b16 v[194:195], v6 offset:22528
    s_add_u32 m0, s45, 57344
    s_add_u32 s32, s48, 622592
    buffer_load_dwordx4 v18, s[12:15], s32 offen lds
    s_waitcnt lgkmcnt(6)
    v_mfma_f32_32x32x16_bf16 v[112:127], v[180:183], v[168:171], v[112:127]
    ds_read_b64_tr_b16 v[196:197], v7 offset:20480
    ds_read_b64_tr_b16 v[198:199], v7 offset:22528
    s_waitcnt lgkmcnt(6)
    v_mfma_f32_32x32x16_bf16 v[128:143], v[184:187], v[168:171], v[128:143]
    ds_read_b64_tr_b16 v[200:201], v8 offset:20480
    ds_read_b64_tr_b16 v[202:203], v8 offset:22528
    s_waitcnt lgkmcnt(6)
    v_mfma_f32_32x32x16_bf16 v[144:159], v[188:191], v[168:171], v[144:159]
    ds_read_b64_tr_b16 v[204:205], v9 offset:20480
    ds_read_b64_tr_b16 v[206:207], v9 offset:22528
    s_waitcnt vmcnt(16)
    s_barrier
    s_waitcnt lgkmcnt(6)
    v_mfma_f32_32x32x16_bf16 v[96:111], v[192:195], v[172:175], v[96:111]
    ds_read_b64_tr_b16 v[176:177], v10 offset:0
    ds_read_b64_tr_b16 v[178:179], v10 offset:2048
    s_waitcnt lgkmcnt(6)
    v_mfma_f32_32x32x16_bf16 v[112:127], v[196:199], v[172:175], v[112:127]
    ds_read_b64_tr_b16 v[180:181], v11 offset:0
    ds_read_b64_tr_b16 v[182:183], v11 offset:2048
    s_waitcnt lgkmcnt(6)
    v_mfma_f32_32x32x16_bf16 v[128:143], v[200:203], v[172:175], v[128:143]
    ds_read_b64_tr_b16 v[184:185], v12 offset:0
    ds_read_b64_tr_b16 v[186:187], v12 offset:2048
    s_waitcnt lgkmcnt(6)
    v_mfma_f32_32x32x16_bf16 v[144:159], v[204:207], v[172:175], v[144:159]
    ds_read_b64_tr_b16 v[188:189], v13 offset:0
    ds_read_b64_tr_b16 v[190:191], v13 offset:2048
    s_waitcnt vmcnt(15)
    s_waitcnt lgkmcnt(6)
    v_mfma_f32_32x32x16_bf16 v[96:111], v[176:179], v[32:35], v[96:111]
    ds_read_b64_tr_b16 v[192:193], v10 offset:4096
    ds_read_b64_tr_b16 v[194:195], v10 offset:6144
    s_waitcnt lgkmcnt(6)
    v_mfma_f32_32x32x16_bf16 v[112:127], v[180:183], v[32:35], v[112:127]
    ds_read_b64_tr_b16 v[196:197], v11 offset:4096
    ds_read_b64_tr_b16 v[198:199], v11 offset:6144
    s_waitcnt lgkmcnt(6)
    v_mfma_f32_32x32x16_bf16 v[128:143], v[184:187], v[32:35], v[128:143]
    ds_read_b64_tr_b16 v[200:201], v12 offset:4096
    ds_read_b64_tr_b16 v[202:203], v12 offset:6144
    s_waitcnt lgkmcnt(6)
    v_mfma_f32_32x32x16_bf16 v[144:159], v[188:191], v[32:35], v[144:159]
    ds_read_b64_tr_b16 v[204:205], v13 offset:4096
    ds_read_b64_tr_b16 v[206:207], v13 offset:6144
    s_waitcnt vmcnt(14)
    s_waitcnt lgkmcnt(6)
    v_mfma_f32_32x32x16_bf16 v[96:111], v[192:195], v[36:39], v[96:111]
    ds_read_b64_tr_b16 v[176:177], v10 offset:16384
    ds_read_b64_tr_b16 v[178:179], v10 offset:18432
    s_waitcnt lgkmcnt(6)
    v_mfma_f32_32x32x16_bf16 v[112:127], v[196:199], v[36:39], v[112:127]
    ds_read_b64_tr_b16 v[180:181], v11 offset:16384
    ds_read_b64_tr_b16 v[182:183], v11 offset:18432
    s_waitcnt lgkmcnt(6)
    v_mfma_f32_32x32x16_bf16 v[128:143], v[200:203], v[36:39], v[128:143]
    ds_read_b64_tr_b16 v[184:185], v12 offset:16384
    ds_read_b64_tr_b16 v[186:187], v12 offset:18432
    s_waitcnt lgkmcnt(6)
    v_mfma_f32_32x32x16_bf16 v[144:159], v[204:207], v[36:39], v[144:159]
    ds_read_b64_tr_b16 v[188:189], v13 offset:16384
    ds_read_b64_tr_b16 v[190:191], v13 offset:18432
    s_waitcnt vmcnt(13)
    s_waitcnt lgkmcnt(6)
    v_mfma_f32_32x32x16_bf16 v[96:111], v[176:179], v[40:43], v[96:111]
    ds_read_b64_tr_b16 v[192:193], v10 offset:20480
    ds_read_b64_tr_b16 v[194:195], v10 offset:22528
    s_waitcnt lgkmcnt(6)
    v_mfma_f32_32x32x16_bf16 v[112:127], v[180:183], v[40:43], v[112:127]
    ds_read_b64_tr_b16 v[196:197], v11 offset:20480
    ds_read_b64_tr_b16 v[198:199], v11 offset:22528
    s_waitcnt lgkmcnt(6)
    v_mfma_f32_32x32x16_bf16 v[128:143], v[184:187], v[40:43], v[128:143]
    ds_read_b64_tr_b16 v[200:201], v12 offset:20480
    ds_read_b64_tr_b16 v[202:203], v12 offset:22528
    s_waitcnt lgkmcnt(6)
    v_mfma_f32_32x32x16_bf16 v[144:159], v[188:191], v[40:43], v[144:159]
    ds_read_b64_tr_b16 v[204:205], v13 offset:20480
    ds_read_b64_tr_b16 v[206:207], v13 offset:22528
    s_waitcnt vmcnt(12)
    s_waitcnt lgkmcnt(6)
    v_mfma_f32_32x32x16_bf16 v[96:111], v[192:195], v[44:47], v[96:111]
    ds_read_b64_tr_b16 v[176:177], v10 offset:32768
    ds_read_b64_tr_b16 v[178:179], v10 offset:34816
    s_waitcnt lgkmcnt(6)
    v_mfma_f32_32x32x16_bf16 v[112:127], v[196:199], v[44:47], v[112:127]
    ds_read_b64_tr_b16 v[180:181], v11 offset:32768
    ds_read_b64_tr_b16 v[182:183], v11 offset:34816
    s_waitcnt lgkmcnt(6)
    v_mfma_f32_32x32x16_bf16 v[128:143], v[200:203], v[44:47], v[128:143]
    ds_read_b64_tr_b16 v[184:185], v12 offset:32768
    ds_read_b64_tr_b16 v[186:187], v12 offset:34816
    s_waitcnt lgkmcnt(6)
    v_mfma_f32_32x32x16_bf16 v[144:159], v[204:207], v[44:47], v[144:159]
    ds_read_b64_tr_b16 v[188:189], v13 offset:32768
    ds_read_b64_tr_b16 v[190:191], v13 offset:34816
    s_waitcnt vmcnt(11)
    s_waitcnt lgkmcnt(6)
    v_mfma_f32_32x32x16_bf16 v[96:111], v[176:179], v[48:51], v[96:111]
    ds_read_b64_tr_b16 v[192:193], v10 offset:36864
    ds_read_b64_tr_b16 v[194:195], v10 offset:38912
    s_waitcnt lgkmcnt(6)
    v_mfma_f32_32x32x16_bf16 v[112:127], v[180:183], v[48:51], v[112:127]
    ds_read_b64_tr_b16 v[196:197], v11 offset:36864
    ds_read_b64_tr_b16 v[198:199], v11 offset:38912
    s_waitcnt lgkmcnt(6)
    v_mfma_f32_32x32x16_bf16 v[128:143], v[184:187], v[48:51], v[128:143]
    ds_read_b64_tr_b16 v[200:201], v12 offset:36864
    ds_read_b64_tr_b16 v[202:203], v12 offset:38912
    s_waitcnt lgkmcnt(6)
    v_mfma_f32_32x32x16_bf16 v[144:159], v[188:191], v[48:51], v[144:159]
    ds_read_b64_tr_b16 v[204:205], v13 offset:36864
    ds_read_b64_tr_b16 v[206:207], v13 offset:38912
    s_waitcnt vmcnt(10)
    s_waitcnt lgkmcnt(6)
    v_mfma_f32_32x32x16_bf16 v[96:111], v[192:195], v[52:55], v[96:111]
    ds_read_b64_tr_b16 v[176:177], v10 offset:49152
    ds_read_b64_tr_b16 v[178:179], v10 offset:51200
    s_waitcnt lgkmcnt(6)
    v_mfma_f32_32x32x16_bf16 v[112:127], v[196:199], v[52:55], v[112:127]
    ds_read_b64_tr_b16 v[180:181], v11 offset:49152
    ds_read_b64_tr_b16 v[182:183], v11 offset:51200
    s_waitcnt lgkmcnt(6)
    v_mfma_f32_32x32x16_bf16 v[128:143], v[200:203], v[52:55], v[128:143]
    ds_read_b64_tr_b16 v[184:185], v12 offset:49152
    ds_read_b64_tr_b16 v[186:187], v12 offset:51200
    s_waitcnt lgkmcnt(6)
    v_mfma_f32_32x32x16_bf16 v[144:159], v[204:207], v[52:55], v[144:159]
    ds_read_b64_tr_b16 v[188:189], v13 offset:49152
    ds_read_b64_tr_b16 v[190:191], v13 offset:51200
    s_waitcnt vmcnt(9)
    s_waitcnt lgkmcnt(6)
    v_mfma_f32_32x32x16_bf16 v[96:111], v[176:179], v[56:59], v[96:111]
    ds_read_b64_tr_b16 v[192:193], v10 offset:53248
    ds_read_b64_tr_b16 v[194:195], v10 offset:55296
    s_waitcnt lgkmcnt(6)
    v_mfma_f32_32x32x16_bf16 v[112:127], v[180:183], v[56:59], v[112:127]
    ds_read_b64_tr_b16 v[196:197], v11 offset:53248
    ds_read_b64_tr_b16 v[198:199], v11 offset:55296
    s_waitcnt lgkmcnt(6)
    v_mfma_f32_32x32x16_bf16 v[128:143], v[184:187], v[56:59], v[128:143]
    ds_read_b64_tr_b16 v[200:201], v12 offset:53248
    ds_read_b64_tr_b16 v[202:203], v12 offset:55296
    s_waitcnt lgkmcnt(6)
    v_mfma_f32_32x32x16_bf16 v[144:159], v[188:191], v[56:59], v[144:159]
    ds_read_b64_tr_b16 v[204:205], v13 offset:53248
    ds_read_b64_tr_b16 v[206:207], v13 offset:55296
    s_waitcnt vmcnt(0)
    s_barrier
    s_waitcnt lgkmcnt(6)
    v_mfma_f32_32x32x16_bf16 v[96:111], v[192:195], v[60:63], v[96:111]
    ds_read_b64_tr_b16 v[176:177], v2 offset:0
    ds_read_b64_tr_b16 v[178:179], v2 offset:2048
    s_waitcnt lgkmcnt(6)
    v_mfma_f32_32x32x16_bf16 v[112:127], v[196:199], v[60:63], v[112:127]
    ds_read_b64_tr_b16 v[180:181], v3 offset:0
    ds_read_b64_tr_b16 v[182:183], v3 offset:2048
    s_waitcnt lgkmcnt(6)
    v_mfma_f32_32x32x16_bf16 v[128:143], v[200:203], v[60:63], v[128:143]
    ds_read_b64_tr_b16 v[184:185], v4 offset:0
    ds_read_b64_tr_b16 v[186:187], v4 offset:2048
    s_waitcnt lgkmcnt(6)
    v_mfma_f32_32x32x16_bf16 v[144:159], v[204:207], v[60:63], v[144:159]
    ds_read_b64_tr_b16 v[188:189], v5 offset:0
    ds_read_b64_tr_b16 v[190:191], v5 offset:2048
    s_waitcnt lgkmcnt(6)
    v_mfma_f32_32x32x16_bf16 v[96:111], v[176:179], v[64:67], v[96:111]
    ds_read_b64_tr_b16 v[192:193], v2 offset:4096
    ds_read_b64_tr_b16 v[194:195], v2 offset:6144
    s_waitcnt lgkmcnt(6)
    v_mfma_f32_32x32x16_bf16 v[112:127], v[180:183], v[64:67], v[112:127]
    ds_read_b64_tr_b16 v[196:197], v3 offset:4096
    ds_read_b64_tr_b16 v[198:199], v3 offset:6144
    s_waitcnt lgkmcnt(6)
    v_mfma_f32_32x32x16_bf16 v[128:143], v[184:187], v[64:67], v[128:143]
    ds_read_b64_tr_b16 v[200:201], v4 offset:4096
    ds_read_b64_tr_b16 v[202:203], v4 offset:6144
    s_waitcnt lgkmcnt(6)
    v_mfma_f32_32x32x16_bf16 v[144:159], v[188:191], v[64:67], v[144:159]
    ds_read_b64_tr_b16 v[204:205], v5 offset:4096
    ds_read_b64_tr_b16 v[206:207], v5 offset:6144
    s_waitcnt lgkmcnt(6)
    v_mfma_f32_32x32x16_bf16 v[96:111], v[192:195], v[68:71], v[96:111]
    ds_read_b64_tr_b16 v[176:177], v2 offset:49152
    ds_read_b64_tr_b16 v[178:179], v2 offset:51200
    s_waitcnt lgkmcnt(6)
    v_mfma_f32_32x32x16_bf16 v[112:127], v[196:199], v[68:71], v[112:127]
    ds_read_b64_tr_b16 v[180:181], v3 offset:49152
    ds_read_b64_tr_b16 v[182:183], v3 offset:51200
    s_waitcnt lgkmcnt(6)
    v_mfma_f32_32x32x16_bf16 v[128:143], v[200:203], v[68:71], v[128:143]
    ds_read_b64_tr_b16 v[184:185], v4 offset:49152
    ds_read_b64_tr_b16 v[186:187], v4 offset:51200
    s_waitcnt lgkmcnt(6)
    v_mfma_f32_32x32x16_bf16 v[144:159], v[204:207], v[68:71], v[144:159]
    ds_read_b64_tr_b16 v[188:189], v5 offset:49152
    ds_read_b64_tr_b16 v[190:191], v5 offset:51200
    s_waitcnt lgkmcnt(6)
    v_mfma_f32_32x32x16_bf16 v[96:111], v[176:179], v[72:75], v[96:111]
    ds_read_b64_tr_b16 v[192:193], v2 offset:53248
    ds_read_b64_tr_b16 v[194:195], v2 offset:55296
    s_waitcnt lgkmcnt(6)
    v_mfma_f32_32x32x16_bf16 v[112:127], v[180:183], v[72:75], v[112:127]
    ds_read_b64_tr_b16 v[196:197], v3 offset:53248
    ds_read_b64_tr_b16 v[198:199], v3 offset:55296
    s_waitcnt lgkmcnt(6)
    v_mfma_f32_32x32x16_bf16 v[128:143], v[184:187], v[72:75], v[128:143]
    ds_read_b64_tr_b16 v[200:201], v4 offset:53248
    ds_read_b64_tr_b16 v[202:203], v4 offset:55296
    s_waitcnt lgkmcnt(6)
    v_mfma_f32_32x32x16_bf16 v[144:159], v[188:191], v[72:75], v[144:159]
    ds_read_b64_tr_b16 v[204:205], v5 offset:53248
    ds_read_b64_tr_b16 v[206:207], v5 offset:55296
    s_waitcnt lgkmcnt(6)
    v_mfma_f32_32x32x16_bf16 v[96:111], v[192:195], v[76:79], v[96:111]
    s_waitcnt lgkmcnt(4)
    v_mfma_f32_32x32x16_bf16 v[112:127], v[196:199], v[76:79], v[112:127]
    s_waitcnt lgkmcnt(2)
    v_mfma_f32_32x32x16_bf16 v[128:143], v[200:203], v[76:79], v[128:143]
    s_waitcnt lgkmcnt(0)
    v_mfma_f32_32x32x16_bf16 v[144:159], v[204:207], v[76:79], v[144:159]
    s_lshl_b32 s21, s3, 13
    s_add_u32 s22, s21, 65536
    v_add_u32 v28, s22, v30
    s_xor_b32 s21, s21, 32768
    s_add_u32 s22, s21, 65536
    v_add_u32 v29, s22, v30
    s_lshl_b32 s21, s6, 3
    s_add_u32 s21, s21, s7
    s_lshl_b32 s21, s21, 2
    s_add_u32 s21, s21, s82
    s_lshl_b32 s21, s21, 18
    s_lshl_b32 s22, s5, 16
    s_lshl_b32 s23, s83, 14
    s_add_u32 s22, s22, s23
    s_lshl_b32 s23, s4, 13
    s_add_u32 s22, s22, s23
    s_add_u32 s22, s22, s21
    s_nop 7

    s_cmp_eq_u32 s4, 0
    s_cbranch_scc0 R1_29
    ds_write_b128 v28, v[128:131] offset:0
    ds_write_b128 v28, v[132:135] offset:1024
    ds_write_b128 v28, v[136:139] offset:2048
    ds_write_b128 v28, v[140:143] offset:3072
    ds_write_b128 v28, v[144:147] offset:4096
    ds_write_b128 v28, v[148:151] offset:5120
    ds_write_b128 v28, v[152:155] offset:6144
    ds_write_b128 v28, v[156:159] offset:7168
    s_waitcnt lgkmcnt(0)
    s_barrier
    ds_read_b128 v[200:203], v29 offset:0
    ds_read_b128 v[204:207], v29 offset:1024
    ds_read_b128 v[208:211], v29 offset:2048
    ds_read_b128 v[212:215], v29 offset:3072
    ds_read_b128 v[232:235], v29 offset:4096
    ds_read_b128 v[236:239], v29 offset:5120
    ds_read_b128 v[240:243], v29 offset:6144
    ds_read_b128 v[244:247], v29 offset:7168
    s_cmp_eq_u32 s5, s83
    s_cbranch_scc1 own_31
    s_waitcnt lgkmcnt(7)
    v_pk_add_f32 v[96:97], v[96:97], v[200:201]
    v_pk_add_f32 v[98:99], v[98:99], v[202:203]
    v_cvt_pk_bf16_f32 v32, v96, v97
    v_cvt_pk_bf16_f32 v33, v98, v99
    s_waitcnt lgkmcnt(6)
    v_pk_add_f32 v[100:101], v[100:101], v[204:205]
    v_pk_add_f32 v[102:103], v[102:103], v[206:207]
    v_cvt_pk_bf16_f32 v34, v100, v101
    v_cvt_pk_bf16_f32 v35, v102, v103
    buffer_store_dwordx4 v[32:35], v30, s[92:95], s22 offen offset:0 sc1
    s_waitcnt lgkmcnt(5)
    v_pk_add_f32 v[104:105], v[104:105], v[208:209]
    v_pk_add_f32 v[106:107], v[106:107], v[210:211]
    v_cvt_pk_bf16_f32 v36, v104, v105
    v_cvt_pk_bf16_f32 v37, v106, v107
    s_waitcnt lgkmcnt(4)
    v_pk_add_f32 v[108:109], v[108:109], v[212:213]
    v_pk_add_f32 v[110:111], v[110:111], v[214:215]
    v_cvt_pk_bf16_f32 v38, v108, v109
    v_cvt_pk_bf16_f32 v39, v110, v111
    buffer_store_dwordx4 v[36:39], v30, s[92:95], s22 offen offset:1024 sc1
    s_waitcnt lgkmcnt(3)
    v_pk_add_f32 v[112:113], v[112:113], v[232:233]
    v_pk_add_f32 v[114:115], v[114:115], v[234:235]
    v_cvt_pk_bf16_f32 v40, v112, v113
    v_cvt_pk_bf16_f32 v41, v114, v115
    s_waitcnt lgkmcnt(2)
    v_pk_add_f32 v[116:117], v[116:117], v[236:237]
    v_pk_add_f32 v[118:119], v[118:119], v[238:239]
    v_cvt_pk_bf16_f32 v42, v116, v117
    v_cvt_pk_bf16_f32 v43, v118, v119
    buffer_store_dwordx4 v[40:43], v30, s[92:95], s22 offen offset:2048 sc1
    s_waitcnt lgkmcnt(1)
    v_pk_add_f32 v[120:121], v[120:121], v[240:241]
    v_pk_add_f32 v[122:123], v[122:123], v[242:243]
    v_cvt_pk_bf16_f32 v44, v120, v121
    v_cvt_pk_bf16_f32 v45, v122, v123
    s_waitcnt lgkmcnt(0)
    v_pk_add_f32 v[124:125], v[124:125], v[244:245]
    v_pk_add_f32 v[126:127], v[126:127], v[246:247]
    v_cvt_pk_bf16_f32 v46, v124, v125
    v_cvt_pk_bf16_f32 v47, v126, v127
    buffer_store_dwordx4 v[44:47], v30, s[92:95], s22 offen offset:3072 sc1
    s_branch sent_32
own_31:
    s_lshl_b32 s23, s4, 13
    v_add_u32 v20, s23, v30
    s_waitcnt lgkmcnt(7)
    v_pk_add_f32 v[96:97], v[96:97], v[200:201]
    v_pk_add_f32 v[98:99], v[98:99], v[202:203]
    ds_write_b128 v20, v[96:99] offset:0
    s_waitcnt lgkmcnt(6)
    v_pk_add_f32 v[100:101], v[100:101], v[204:205]
    v_pk_add_f32 v[102:103], v[102:103], v[206:207]
    ds_write_b128 v20, v[100:103] offset:1024
    s_waitcnt lgkmcnt(5)
    v_pk_add_f32 v[104:105], v[104:105], v[208:209]
    v_pk_add_f32 v[106:107], v[106:107], v[210:211]
    ds_write_b128 v20, v[104:107] offset:2048
    s_waitcnt lgkmcnt(4)
    v_pk_add_f32 v[108:109], v[108:109], v[212:213]
    v_pk_add_f32 v[110:111], v[110:111], v[214:215]
    ds_write_b128 v20, v[108:111] offset:3072
    s_waitcnt lgkmcnt(3)
    v_pk_add_f32 v[112:113], v[112:113], v[232:233]
    v_pk_add_f32 v[114:115], v[114:115], v[234:235]
    ds_write_b128 v20, v[112:115] offset:4096
    s_waitcnt lgkmcnt(2)
    v_pk_add_f32 v[116:117], v[116:117], v[236:237]
    v_pk_add_f32 v[118:119], v[118:119], v[238:239]
    ds_write_b128 v20, v[116:119] offset:5120
    s_waitcnt lgkmcnt(1)
    v_pk_add_f32 v[120:121], v[120:121], v[240:241]
    v_pk_add_f32 v[122:123], v[122:123], v[242:243]
    ds_write_b128 v20, v[120:123] offset:6144
    s_waitcnt lgkmcnt(0)
    v_pk_add_f32 v[124:125], v[124:125], v[244:245]
    v_pk_add_f32 v[126:127], v[126:127], v[246:247]
    ds_write_b128 v20, v[124:127] offset:7168
sent_32:
    s_branch RE_30
R1_29:
    ds_write_b128 v28, v[96:99] offset:0
    ds_write_b128 v28, v[100:103] offset:1024
    ds_write_b128 v28, v[104:107] offset:2048
    ds_write_b128 v28, v[108:111] offset:3072
    ds_write_b128 v28, v[112:115] offset:4096
    ds_write_b128 v28, v[116:119] offset:5120
    ds_write_b128 v28, v[120:123] offset:6144
    ds_write_b128 v28, v[124:127] offset:7168
    s_waitcnt lgkmcnt(0)
    s_barrier
    ds_read_b128 v[200:203], v29 offset:0
    ds_read_b128 v[204:207], v29 offset:1024
    ds_read_b128 v[208:211], v29 offset:2048
    ds_read_b128 v[212:215], v29 offset:3072
    ds_read_b128 v[232:235], v29 offset:4096
    ds_read_b128 v[236:239], v29 offset:5120
    ds_read_b128 v[240:243], v29 offset:6144
    ds_read_b128 v[244:247], v29 offset:7168
    s_cmp_eq_u32 s5, s83
    s_cbranch_scc1 own_33
    s_waitcnt lgkmcnt(7)
    v_pk_add_f32 v[128:129], v[128:129], v[200:201]
    v_pk_add_f32 v[130:131], v[130:131], v[202:203]
    v_cvt_pk_bf16_f32 v32, v128, v129
    v_cvt_pk_bf16_f32 v33, v130, v131
    s_waitcnt lgkmcnt(6)
    v_pk_add_f32 v[132:133], v[132:133], v[204:205]
    v_pk_add_f32 v[134:135], v[134:135], v[206:207]
    v_cvt_pk_bf16_f32 v34, v132, v133
    v_cvt_pk_bf16_f32 v35, v134, v135
    buffer_store_dwordx4 v[32:35], v30, s[92:95], s22 offen offset:0 sc1
    s_waitcnt lgkmcnt(5)
    v_pk_add_f32 v[136:137], v[136:137], v[208:209]
    v_pk_add_f32 v[138:139], v[138:139], v[210:211]
    v_cvt_pk_bf16_f32 v36, v136, v137
    v_cvt_pk_bf16_f32 v37, v138, v139
    s_waitcnt lgkmcnt(4)
    v_pk_add_f32 v[140:141], v[140:141], v[212:213]
    v_pk_add_f32 v[142:143], v[142:143], v[214:215]
    v_cvt_pk_bf16_f32 v38, v140, v141
    v_cvt_pk_bf16_f32 v39, v142, v143
    buffer_store_dwordx4 v[36:39], v30, s[92:95], s22 offen offset:1024 sc1
    s_waitcnt lgkmcnt(3)
    v_pk_add_f32 v[144:145], v[144:145], v[232:233]
    v_pk_add_f32 v[146:147], v[146:147], v[234:235]
    v_cvt_pk_bf16_f32 v40, v144, v145
    v_cvt_pk_bf16_f32 v41, v146, v147
    s_waitcnt lgkmcnt(2)
    v_pk_add_f32 v[148:149], v[148:149], v[236:237]
    v_pk_add_f32 v[150:151], v[150:151], v[238:239]
    v_cvt_pk_bf16_f32 v42, v148, v149
    v_cvt_pk_bf16_f32 v43, v150, v151
    buffer_store_dwordx4 v[40:43], v30, s[92:95], s22 offen offset:2048 sc1
    s_waitcnt lgkmcnt(1)
    v_pk_add_f32 v[152:153], v[152:153], v[240:241]
    v_pk_add_f32 v[154:155], v[154:155], v[242:243]
    v_cvt_pk_bf16_f32 v44, v152, v153
    v_cvt_pk_bf16_f32 v45, v154, v155
    s_waitcnt lgkmcnt(0)
    v_pk_add_f32 v[156:157], v[156:157], v[244:245]
    v_pk_add_f32 v[158:159], v[158:159], v[246:247]
    v_cvt_pk_bf16_f32 v46, v156, v157
    v_cvt_pk_bf16_f32 v47, v158, v159
    buffer_store_dwordx4 v[44:47], v30, s[92:95], s22 offen offset:3072 sc1
    s_branch sent_34
own_33:
    s_lshl_b32 s23, s4, 13
    v_add_u32 v20, s23, v30
    s_waitcnt lgkmcnt(7)
    v_pk_add_f32 v[128:129], v[128:129], v[200:201]
    v_pk_add_f32 v[130:131], v[130:131], v[202:203]
    ds_write_b128 v20, v[128:131] offset:0
    s_waitcnt lgkmcnt(6)
    v_pk_add_f32 v[132:133], v[132:133], v[204:205]
    v_pk_add_f32 v[134:135], v[134:135], v[206:207]
    ds_write_b128 v20, v[132:135] offset:1024
    s_waitcnt lgkmcnt(5)
    v_pk_add_f32 v[136:137], v[136:137], v[208:209]
    v_pk_add_f32 v[138:139], v[138:139], v[210:211]
    ds_write_b128 v20, v[136:139] offset:2048
    s_waitcnt lgkmcnt(4)
    v_pk_add_f32 v[140:141], v[140:141], v[212:213]
    v_pk_add_f32 v[142:143], v[142:143], v[214:215]
    ds_write_b128 v20, v[140:143] offset:3072
    s_waitcnt lgkmcnt(3)
    v_pk_add_f32 v[144:145], v[144:145], v[232:233]
    v_pk_add_f32 v[146:147], v[146:147], v[234:235]
    ds_write_b128 v20, v[144:147] offset:4096
    s_waitcnt lgkmcnt(2)
    v_pk_add_f32 v[148:149], v[148:149], v[236:237]
    v_pk_add_f32 v[150:151], v[150:151], v[238:239]
    ds_write_b128 v20, v[148:151] offset:5120
    s_waitcnt lgkmcnt(1)
    v_pk_add_f32 v[152:153], v[152:153], v[240:241]
    v_pk_add_f32 v[154:155], v[154:155], v[242:243]
    ds_write_b128 v20, v[152:155] offset:6144
    s_waitcnt lgkmcnt(0)
    v_pk_add_f32 v[156:157], v[156:157], v[244:245]
    v_pk_add_f32 v[158:159], v[158:159], v[246:247]
    ds_write_b128 v20, v[156:159] offset:7168
sent_34:
RE_30:
    s_waitcnt vmcnt(0) lgkmcnt(0)
    s_barrier
    s_cmp_eq_u32 s3, 7
    s_cbranch_scc0 nf_35
    v_mov_b32 v254, 0
    v_mov_b32 v255, 1
    s_mov_b64 exec, 1
    buffer_store_dword v255, v254, s[88:91], s75 offen offset:8 sc1
    s_mov_b64 exec, -1
nf_35:

    s_cmp_eq_u32 s3, 0
    s_cbranch_scc0 si_36
    buffer_load_dword v251, v249, s[88:91], s55 offen offset:8 sc1
si_36:
    s_lshl_b32 s23, s3, 11
    v_add_u32 v20, s23, v30
    ds_read_b128 v[176:179], v20
    ds_read_b128 v[180:183], v20 offset:1024
    s_lshl_b32 s22, s83, 16
    s_add_u32 s21, s21, s22
    s_and_b32 s23, s3, 3
    s_lshl_b32 s23, s23, 10
    s_lshl_b32 s22, s4, 13
    s_add_u32 s21, s21, s22
    s_add_u32 s21, s21, s23
    v_and_b32 v21, 0x1f0, v30
    v_lshlrev_b32 v21, 7, v21
    v_lshrrev_b32 v22, 9, v30
    v_lshl_or_b32 v21, v22, 4, v21

    s_cmp_eq_u32 s3, 0
    s_cbranch_scc0 sc_37
    s_waitcnt vmcnt(0)
    s_mov_b32 s35, 0
plp_39:
    v_cmp_ne_u32 vcc, 1, v251
    s_lshl_b32 s34, 1, s83
    s_andn2_b32 s34, vcc_lo, s34
    s_and_b32 s34, s34, 15
    s_cbranch_scc0 pok_38
    s_add_u32 s35, s35, 1
    s_cmp_ge_u32 s35, 50000
    s_cbranch_scc1 pok_38
    buffer_load_dword v251, v249, s[88:91], s55 offen offset:8 sc1
    s_waitcnt vmcnt(0)
    s_branch plp_39
pok_38:
sc_37:
    s_barrier
    s_add_u32 s22, s83, 1
    s_and_b32 s22, s22, 3
    s_lshl_b32 s22, s22, 14
    s_add_u32 s22, s22, s21

    buffer_load_dwordx4 v[96:99], v30, s[92:95], s22 offen sc1
    s_add_u32 s22, s83, 2
    s_and_b32 s22, s22, 3
    s_lshl_b32 s22, s22, 14
    s_add_u32 s22, s22, s21

    buffer_load_dwordx4 v[104:107], v30, s[92:95], s22 offen sc1
    s_add_u32 s22, s83, 3
    s_and_b32 s22, s22, 3
    s_lshl_b32 s22, s22, 14
    s_add_u32 s22, s22, s21

    buffer_load_dwordx4 v[112:115], v30, s[92:95], s22 offen sc1
    s_lshl_b32 s22, s83, 16
    s_lshl_b32 s23, s6, 10
    s_add_u32 s22, s22, s23
    s_lshl_b32 s23, s82, 8
    s_add_u32 s22, s22, s23
    s_lshl_b32 s23, s3, 5
    s_add_u32 s22, s22, s23
    s_waitcnt lgkmcnt(0)

    s_waitcnt vmcnt(2)
    v_lshlrev_b32 v100, 16, v96
    v_and_b32 v101, 0xffff0000, v96
    v_pk_add_f32 v[176:177], v[176:177], v[100:101]
    v_lshlrev_b32 v100, 16, v97
    v_and_b32 v101, 0xffff0000, v97
    v_pk_add_f32 v[178:179], v[178:179], v[100:101]
    v_lshlrev_b32 v100, 16, v98
    v_and_b32 v101, 0xffff0000, v98
    v_pk_add_f32 v[180:181], v[180:181], v[100:101]
    v_lshlrev_b32 v100, 16, v99
    v_and_b32 v101, 0xffff0000, v99
    v_pk_add_f32 v[182:183], v[182:183], v[100:101]
    s_waitcnt vmcnt(1)
    v_lshlrev_b32 v108, 16, v104
    v_and_b32 v109, 0xffff0000, v104
    v_pk_add_f32 v[176:177], v[176:177], v[108:109]
    v_lshlrev_b32 v108, 16, v105
    v_and_b32 v109, 0xffff0000, v105
    v_pk_add_f32 v[178:179], v[178:179], v[108:109]
    v_lshlrev_b32 v108, 16, v106
    v_and_b32 v109, 0xffff0000, v106
    v_pk_add_f32 v[180:181], v[180:181], v[108:109]
    v_lshlrev_b32 v108, 16, v107
    v_and_b32 v109, 0xffff0000, v107
    v_pk_add_f32 v[182:183], v[182:183], v[108:109]
    s_waitcnt vmcnt(0)
    v_lshlrev_b32 v116, 16, v112
    v_and_b32 v117, 0xffff0000, v112
    v_pk_add_f32 v[176:177], v[176:177], v[116:117]
    v_lshlrev_b32 v116, 16, v113
    v_and_b32 v117, 0xffff0000, v113
    v_pk_add_f32 v[178:179], v[178:179], v[116:117]
    v_lshlrev_b32 v116, 16, v114
    v_and_b32 v117, 0xffff0000, v114
    v_pk_add_f32 v[180:181], v[180:181], v[116:117]
    v_lshlrev_b32 v116, 16, v115
    v_and_b32 v117, 0xffff0000, v115
    v_pk_add_f32 v[182:183], v[182:183], v[116:117]
    v_cvt_pk_bf16_f32 v192, v176, v177
    v_cvt_pk_bf16_f32 v193, v178, v179
    v_cvt_pk_bf16_f32 v194, v180, v181
    v_cvt_pk_bf16_f32 v195, v182, v183
    buffer_store_dwordx4 v[192:195], v21, s[8:11], s22 offen

    s_endpgm
L_rare:
    v_max3_f32 v20, v176, v177, v178
    v_max3_f32 v20, v20, v179, v180
    v_max3_f32 v20, v20, v181, v182
    v_max3_f32 v20, v20, v183, v184
    v_max3_f32 v20, v20, v185, v186
    v_max3_f32 v20, v20, v187, v188
    v_max3_f32 v20, v20, v189, v190
    v_max_f32 v20, v20, v191
    v_mov_b32 v21, v20
    s_nop 1
    v_permlane32_swap_b32 v20, v21
    v_max_f32 v20, v20, v21
    v_max_f32 v20, 0, v20
    v_sub_f32 v21, 0, v20
    v_exp_f32 v21, v21
    v_sub_f32 v176, v176, v20
    v_sub_f32 v177, v177, v20
    v_sub_f32 v178, v178, v20
    v_sub_f32 v179, v179, v20
    v_sub_f32 v180, v180, v20
    v_sub_f32 v181, v181, v20
    v_sub_f32 v182, v182, v20
    v_sub_f32 v183, v183, v20
    v_sub_f32 v184, v184, v20
    v_sub_f32 v185, v185, v20
    v_sub_f32 v186, v186, v20
    v_sub_f32 v187, v187, v20
    v_sub_f32 v188, v188, v20
    v_sub_f32 v189, v189, v20
    v_sub_f32 v190, v190, v20
    v_sub_f32 v191, v191, v20
    v_sub_f32 v160, v160, v20
    v_sub_f32 v161, v161, v20
    v_sub_f32 v162, v162, v20
    v_sub_f32 v163, v163, v20
    v_sub_f32 v164, v164, v20
    v_sub_f32 v165, v165, v20
    v_sub_f32 v166, v166, v20
    v_sub_f32 v167, v167, v20
    v_sub_f32 v168, v168, v20
    v_sub_f32 v169, v169, v20
    v_sub_f32 v170, v170, v20
    v_sub_f32 v171, v171, v20
    v_sub_f32 v172, v172, v20
    v_sub_f32 v173, v173, v20
    v_sub_f32 v174, v174, v20
    v_sub_f32 v175, v175, v20
    v_mul_f32 v96, v96, v21
    v_mul_f32 v97, v97, v21
    v_mul_f32 v98, v98, v21
    v_mul_f32 v99, v99, v21
    v_mul_f32 v100, v100, v21
    v_mul_f32 v101, v101, v21
    v_mul_f32 v102, v102, v21
    v_mul_f32 v103, v103, v21
    v_mul_f32 v104, v104, v21
    v_mul_f32 v105, v105, v21
    v_mul_f32 v106, v106, v21
    v_mul_f32 v107, v107, v21
    v_mul_f32 v108, v108, v21
    v_mul_f32 v109, v109, v21
    v_mul_f32 v110, v110, v21
    v_mul_f32 v111, v111, v21
    v_mul_f32 v112, v112, v21
    v_mul_f32 v113, v113, v21
    v_mul_f32 v114, v114, v21
    v_mul_f32 v115, v115, v21
    v_mul_f32 v116, v116, v21
    v_mul_f32 v117, v117, v21
    v_mul_f32 v118, v118, v21
    v_mul_f32 v119, v119, v21
    v_mul_f32 v120, v120, v21
    v_mul_f32 v121, v121, v21
    v_mul_f32 v122, v122, v21
    v_mul_f32 v123, v123, v21
    v_mul_f32 v124, v124, v21
    v_mul_f32 v125, v125, v21
    v_mul_f32 v126, v126, v21
    v_mul_f32 v127, v127, v21
    v_mul_f32 v128, v128, v21
    v_mul_f32 v129, v129, v21
    v_mul_f32 v130, v130, v21
    v_mul_f32 v131, v131, v21
    v_mul_f32 v132, v132, v21
    v_mul_f32 v133, v133, v21
    v_mul_f32 v134, v134, v21
    v_mul_f32 v135, v135, v21
    v_mul_f32 v136, v136, v21
    v_mul_f32 v137, v137, v21
    v_mul_f32 v138, v138, v21
    v_mul_f32 v139, v139, v21
    v_mul_f32 v140, v140, v21
    v_mul_f32 v141, v141, v21
    v_mul_f32 v142, v142, v21
    v_mul_f32 v143, v143, v21
    v_mul_f32 v144, v144, v21
    v_mul_f32 v145, v145, v21
    v_mul_f32 v146, v146, v21
    v_mul_f32 v147, v147, v21
    v_mul_f32 v148, v148, v21
    v_mul_f32 v149, v149, v21
    v_mul_f32 v150, v150, v21
    v_mul_f32 v151, v151, v21
    v_mul_f32 v152, v152, v21
    v_mul_f32 v153, v153, v21
    v_mul_f32 v154, v154, v21
    v_mul_f32 v155, v155, v21
    v_mul_f32 v156, v156, v21
    v_mul_f32 v157, v157, v21
    v_mul_f32 v158, v158, v21
    v_mul_f32 v159, v159, v21
    v_mul_f32 v19, v19, v21
    s_cmp_eq_u32 s41, 1
    s_cbranch_scc1 L_sm1
    s_cmp_eq_u32 s41, 2
    s_cbranch_scc1 L_sm2
    s_cmp_eq_u32 s41, 3
    s_cbranch_scc1 L_sm3
    s_cmp_eq_u32 s41, 4
    s_cbranch_scc1 L_sm4
    s_cmp_eq_u32 s41, 5
    s_cbranch_scc1 L_sm5
    s_cmp_eq_u32 s41, 6
    s_cbranch_scc1 L_sm6
    s_cmp_eq_u32 s41, 7
    s_cbranch_scc1 L_sm7
    s_cmp_eq_u32 s41, 9
    s_cbranch_scc1 L_sm9
    s_cmp_eq_u32 s41, 10
    s_cbranch_scc1 L_sm10
    s_cmp_eq_u32 s41, 11
    s_cbranch_scc1 L_sm11
    s_cmp_eq_u32 s41, 12
    s_cbranch_scc1 L_sm12
    s_cmp_eq_u32 s41, 13
    s_cbranch_scc1 L_sm13
    s_cmp_eq_u32 s41, 14
    s_cbranch_scc1 L_sm14
    s_branch L_sm15
L_end:
    s_endpgm
.section .rodata,"a"
.p2align 6
.amdhsa_kernel concat_heads__mha_block_cached__mha_block_cached__near_ridge_kernel
  .amdhsa_next_free_vgpr 256
  .amdhsa_next_free_sgpr 102
  .amdhsa_accum_offset 256
  .amdhsa_group_segment_fixed_size 0
  .amdhsa_kernarg_size 104
  .amdhsa_user_sgpr_count 2
  .amdhsa_user_sgpr_kernarg_segment_ptr 1
  .amdhsa_system_sgpr_workgroup_id_x 1
  .amdhsa_float_denorm_mode_32 3
.end_amdhsa_kernel
```
